```python
import torch

def _softmax(x, axis=-1):
    return torch.softmax(x, dim=axis)

def _gelu(x):
    return torch.nn.functional.gelu(x, approximate='tanh')

def _silu(x):
    return torch.nn.functional.silu(x)

def _sigmoid(x):
    return torch.sigmoid(x)

def _layernorm(x, axis=-1, eps=1e-05):
    m = x.mean(dim=axis, keepdim=True)
    v = x.var(dim=axis, keepdim=True, unbiased=False)
    return (x - m) / torch.sqrt(v + eps)

def _scatter_add(tgt, idx, src, axis=0):
    return tgt.clone().index_add_(axis, idx, src)

def _segment_sum(src, seg, n):
    out = torch.zeros((n,) + src.shape[1:], dtype=src.dtype)
    return out.index_add_(0, seg, src)

def _pad(x, pw):
    flat = tuple((v for pair in reversed(pw) for v in pair))
    return torch.nn.functional.pad(x, flat)
kernel_name = 'adaLN_cond__sliding_block_cached__mixer_channel_mlp__decode'

def setup_inputs():

    _w = lambda a: (lambda t: t.to(torch.bfloat16) if t.is_floating_point() else t)(torch.as_tensor(a))

    def _A_setup():
        B, Sq, D = (2, 1, 1024)
        Hq, Hkv, Sk, Dh = (32, 4, 32768, 128)
        assert Hq % Hkv == 0, (Hq, Hkv)
        return {'x': _w((lambda *s: torch.randn(*s, dtype=torch.bfloat16) * 0.05)(B, Sq, D)), 'k_cache': _w((lambda *s: torch.randn(*s, dtype=torch.bfloat16) * 3.2)(B, Hkv, Sk, Dh)), 'v_cache': _w((lambda *s: torch.randn(*s, dtype=torch.bfloat16) * 0.4)(B, Hkv, Sk, Dh)), 'wq': _w((lambda *s: torch.randn(*s, dtype=torch.bfloat16) * 3.2)(D, Hq * Dh) * D ** (-0.5)), 'wo': _w((lambda *s: torch.randn(*s, dtype=torch.bfloat16) * 0.4)(Hq * Dh, D) * (Hq * Dh) ** (-0.5))}
    _A_in = _A_setup()

    def _B_setup():
        B, S, D, F = (2, 1, 1024, 3584)
        return {'x': _w((lambda *s: torch.randn(*s, dtype=torch.bfloat16) * 0.05)(B, S, D)), 'w1': _w((lambda *s: torch.randn(*s, dtype=torch.bfloat16) * 3.2)(D, F) * D ** (-0.5)), 'b1': _w((lambda *s: torch.randn(*s, dtype=torch.bfloat16) * 3.2)(F)), 'w2': _w((lambda *s: torch.randn(*s, dtype=torch.bfloat16) * 0.2)(F, D) * F ** (-0.5)), 'b2': _w((lambda *s: torch.randn(*s, dtype=torch.bfloat16) * 0.4)(D))}
    _B_in = _B_setup()
    return {'A_x': _A_in['x'], 'A_k_cache': _A_in['k_cache'], 'A_v_cache': _A_in['v_cache'], 'A_wq': _A_in['wq'], 'A_wo': _A_in['wo'], 'B_x': _B_in['x'], 'B_w1': _B_in['w1'], 'B_b1': _B_in['b1'], 'B_w2': _B_in['w2'], 'B_b2': _B_in['b2'], 'c': _w((lambda *s: torch.randn(*s, dtype=torch.bfloat16) * 0.2)(2, 1024) * 8.0), 'w_mod': _w((lambda *s: torch.randn(*s, dtype=torch.bfloat16) * 0.2)(1024, 6 * 1024) * 1024 ** (-0.5) * 8.0)}

def reference(A_x, A_k_cache, A_v_cache, A_wq, A_wo, B_x, B_w1, B_b1, B_w2, B_b2, c, w_mod):

    def _A_ref(x, k_cache, v_cache, wq, wo):
        B, Sq, D = x.shape
        Hq, Dh = (32, 128)
        Hkv, Sk = (k_cache.shape[1], k_cache.shape[2])
        W = min(4096, max(256, Sk // 4))
        rep = Hq // Hkv
        q = (lambda x, *d: x.permute(*d))((x @ wq).reshape(B, Sq, Hq, Dh), 0, 2, 1, 3)
        k = (lambda x, n, axis: torch.repeat_interleave(x, n, dim=axis))(k_cache[:, :, Sk - W:, :], rep, axis=1)
        v = (lambda x, n, axis: torch.repeat_interleave(x, n, dim=axis))(v_cache[:, :, Sk - W:, :], rep, axis=1)
        scores = torch.einsum('bhqd,bhkd->bhqk', q, k) * Dh ** (-0.5)
        p = _softmax(scores, axis=-1)
        o = torch.einsum('bhqk,bhkd->bhqd', p, v)
        return (lambda x, *d: x.permute(*d))(o, 0, 2, 1, 3).reshape(B, Sq, Hq * Dh) @ wo

    def _B_ref(x, w1, b1, w2, b2):
        y = _layernorm(x, axis=-1)
        h = _gelu(torch.einsum('bsd,df->bsf', y, w1) + b1)
        return torch.einsum('bsf,fd->bsd', h, w2) + b2
    x = A_x
    mod = (_silu(c) @ w_mod).reshape(c.shape[0], 6, 1, -1)
    sa, ca, ga, sb, cb, gb = (mod[:, 0].clone(), mod[:, 1].clone(), mod[:, 2].clone(), mod[:, 3].clone(), mod[:, 4].clone(), mod[:, 5].clone())
    h = _layernorm(x, axis=-1) * (1 + ca) + sa
    x = x + ga * _A_ref(h, A_k_cache, A_v_cache, A_wq, A_wo)
    h = _layernorm(x, axis=-1) * (1 + cb) + sb
    x = x + gb * _B_ref(h, B_w1, B_b1, B_w2, B_b2)
    return x
```

```asm
; @launch grid=(256,1,1) block=(512,1,1) lds=106496
.amdgcn_target "amdgcn-amd-amdhsa--gfx950"
.text
.globl adaLN_cond__sliding_block_cached__mixer_channel_mlp__decode_kernel
.p2align 8
.type adaLN_cond__sliding_block_cached__mixer_channel_mlp__decode_kernel,@function
adaLN_cond__sliding_block_cached__mixer_channel_mlp__decode_kernel:
    s_cmp_ge_u32 s2, 256
    s_cbranch_scc1 L_end
    s_load_dwordx16 s[16:31], s[0:1], 0
    s_load_dwordx8 s[32:39], s[0:1], 64
    s_load_dwordx4 s[40:43], s[0:1], 96
    s_load_dwordx2 s[44:45], s[0:1], 112
    s_getpc_b64 s[60:61]
L_pc:
    v_and_b32 v1, 63, v0
    v_lshrrev_b32 v2, 6, v0
    s_nop 0
    v_readfirstlane_b32 s6, v2
    s_sub_u32 s60, s60, (L_pc - adaLN_cond__sliding_block_cached__mixer_channel_mlp__decode_kernel)
    s_subb_u32 s61, s61, 0
    s_mov_b32 s62, (L_code_end - adaLN_cond__sliding_block_cached__mixer_channel_mlp__decode_kernel)
    s_mov_b32 s63, 0x00020000
    v_lshlrev_b32 v16, 6, v0
    buffer_load_dword v63, v16, s[60:63], 0 offen
    s_and_b32 s7, s2, 7
    s_lshr_b32 s8, s2, 3
    s_mov_b32 s46, 0x05040100
    s_mov_b32 s47, 0x07060302
    s_mov_b32 s71, 0xffff0000
    s_mov_b32 s96, 0
    s_sub_u32 s9, s8, 8
    s_cmp_ge_u32 s9, 16
    s_cbranch_scc1 L_Estart
    s_and_b32 s10, s9, 1
    s_lshl_b32 s74, s7, 3
    s_lshr_b32 s67, s9, 1
    s_add_u32 s12, s74, s67
    s_lshl_b32 s66, s7, 2
    s_add_u32 s13, s66, s67
    s_sub_u32 s13, s13, 4
    s_cmp_ge_u32 s9, 8
    s_cselect_b32 s11, s13, s12
    s_mov_b32 s64, 8192
    s_cselect_b32 s64, 12288, s64
    s_lshl_b32 s65, s11, 7
    v_lshrrev_b32 v16, 3, v1
    v_and_b32 v17, 3, v16
    v_lshlrev_b32 v17, 1, v17
    v_lshrrev_b32 v16, 2, v16
    v_lshlrev_b32 v16, 5, v16
    v_add_u32 v16, v16, v17
    s_lshl_b32 s66, s10, 9
    s_lshl_b32 s67, s6, 6
    s_add_u32 s66, s66, s67
    v_add_u32 v16, s66, v16
    v_mul_lo_u32 v14, v16, s64
    v_and_b32 v17, 7, v1
    v_lshlrev_b32 v17, 4, v17
    v_add_u32 v14, v14, v17
    v_bfe_u32 v16, v1, 4, 1
    v_and_b32 v17, 15, v1
    s_lshl_b32 s67, s6, 4
    v_add_u32 v17, s67, v17
    v_mul_u32_u24 v18, 2176, v16
    v_lshlrev_b32 v19, 3, v17
    v_add_u32 v7, v18, v19
    s_lshl_b32 s66, s10, 7
    v_add_u32 v17, s66, v17
    v_lshrrev_b32 v18, 3, v17
    v_lshlrev_b32 v18, 5, v18
    v_and_b32 v19, 7, v17
    v_add_u32 v18, v18, v19
    v_lshlrev_b32 v18, 1, v18
    v_lshlrev_b32 v19, 11, v16
    v_add_u32 v6, v18, v19
    v_lshlrev_b32 v18, 4, v17
    v_lshlrev_b32 v19, 12, v16
    v_add_u32 v4, v19, v18
    v_lshrrev_b32 v16, 5, v1
    v_lshlrev_b32 v15, 11, v16
    v_and_b32 v17, 31, v1
    v_lshlrev_b32 v17, 6, v17
    v_add_u32 v15, v15, v17
    s_waitcnt lgkmcnt(0)
    s_cmp_ge_u32 s9, 8
    s_cselect_b32 s52, s38, s22
    s_cselect_b32 s53, s39, s23
    s_mov_b32 s54, 8388608
    s_cselect_b32 s54, 12582912, s54
    s_mov_b32 s55, 0x00020000
    s_mov_b32 s56, s36
    s_mov_b32 s57, s37
    s_mov_b32 s58, 4096
    s_mov_b32 s59, 0x00020000
    s_mov_b32 s60, s16
    s_mov_b32 s61, s17
    s_mov_b32 s62, 4096
    s_mov_b32 s63, 0x00020000
    buffer_load_ushort v236, v6, s[56:59], 0 offen offset:0
    buffer_load_ushort v237, v6, s[56:59], 0 offen offset:16
    buffer_load_ushort v238, v6, s[56:59], 0 offen offset:32
    buffer_load_ushort v239, v6, s[56:59], 0 offen offset:48
    s_mul_i32 s66, s64, 0
    s_add_u32 s66, s66, s65
    buffer_load_dwordx4 v[64:67], v14, s[52:55], s66 offen nt
    s_mul_i32 s66, s64, 8
    s_add_u32 s66, s66, s65
    buffer_load_dwordx4 v[68:71], v14, s[52:55], s66 offen nt
    s_mul_i32 s66, s64, 16
    s_add_u32 s66, s66, s65
    buffer_load_dwordx4 v[72:75], v14, s[52:55], s66 offen nt
    s_mul_i32 s66, s64, 24
    s_add_u32 s66, s66, s65
    buffer_load_dwordx4 v[76:79], v14, s[52:55], s66 offen nt
    s_mul_i32 s66, s64, 1
    s_add_u32 s66, s66, s65
    buffer_load_dwordx4 v[80:83], v14, s[52:55], s66 offen nt
    s_mul_i32 s66, s64, 9
    s_add_u32 s66, s66, s65
    buffer_load_dwordx4 v[84:87], v14, s[52:55], s66 offen nt
    s_mul_i32 s66, s64, 17
    s_add_u32 s66, s66, s65
    buffer_load_dwordx4 v[88:91], v14, s[52:55], s66 offen nt
    s_mul_i32 s66, s64, 25
    s_add_u32 s66, s66, s65
    buffer_load_dwordx4 v[92:95], v14, s[52:55], s66 offen nt
    buffer_load_ushort v232, v6, s[60:63], 0 offen offset:0
    buffer_load_ushort v233, v6, s[60:63], 0 offen offset:16
    buffer_load_ushort v234, v6, s[60:63], 0 offen offset:32
    buffer_load_ushort v235, v6, s[60:63], 0 offen offset:48
    buffer_load_dwordx4 v[216:219], v15, s[60:63], 0 offen offset:0
    buffer_load_dwordx4 v[220:223], v15, s[60:63], 0 offen offset:16
    buffer_load_dwordx4 v[224:227], v15, s[60:63], 0 offen offset:32
    buffer_load_dwordx4 v[228:231], v15, s[60:63], 0 offen offset:48
    s_mov_b32 s48, s44
    s_mov_b32 s49, s45
    s_mov_b32 s50, 4194304
    s_mov_b32 s51, 0x00020000
    buffer_load_dword v57, off, s[48:51], 0 sc1
    s_mov_b32 s26, 0xffffff00
    v_and_b32 v16, 1, v1
    v_mul_u32_u24 v18, 2176, v16
    v_lshrrev_b32 v19, 4, v1
    v_lshlrev_b32 v19, 5, v19
    v_add_u32 v18, v18, v19
    v_bfe_u32 v19, v1, 1, 1
    v_lshlrev_b32 v19, 4, v19
    v_add_u32 v18, v18, v19
    s_lshl_b32 s66, s6, 7
    v_add_u32 v18, s66, v18
    s_lshl_b32 s66, s6, 8
    s_add_u32 s66, s66, 4352
    v_mov_b32 v19, s66
    v_bfe_u32 v20, v1, 2, 2
    v_cmp_eq_u32 vcc, 0, v20
    s_nop 1
    v_cndmask_b32 v8, v19, v18, vcc
    v_cmp_eq_u32 vcc, 1, v20
    s_nop 1
    v_cndmask_b32 v9, v19, v18, vcc
    v_cmp_eq_u32 vcc, 2, v20
    s_nop 1
    v_cndmask_b32 v10, v19, v18, vcc
    v_cmp_eq_u32 vcc, 3, v20
    s_nop 1
    v_cndmask_b32 v11, v19, v18, vcc
    v_and_b32 v16, 1, v1
    v_lshlrev_b32 v16, 4, v16
    v_bfe_u32 v17, v1, 4, 1
    v_lshlrev_b32 v17, 3, v17
    v_add_u32 v16, v16, v17
    v_bfe_u32 v17, v1, 2, 2
    v_add_u32 v16, v16, v17
    v_mul_u32_u24 v16, 272, v16
    v_lshrrev_b32 v17, 5, v1
    v_lshlrev_b32 v17, 4, v17
    v_add_u32 v16, v16, v17
    s_lshl_b32 s66, s6, 5
    s_add_u32 s66, s66, 6400
    v_add_u32 v48, s66, v16
    v_lshrrev_b32 v16, 3, v1
    v_lshlrev_b32 v50, 4, v16
    v_mul_u32_u24 v16, 272, v16
    v_and_b32 v17, 7, v1
    v_lshlrev_b32 v17, 5, v17
    v_add_u32 v16, v16, v17
    s_and_b32 s66, s6, 3
    s_mul_i32 s66, s66, 2176
    s_add_u32 s66, s66, 6400
    v_add_u32 v49, s66, v16
    s_lshl_b32 s66, s6, 8
    s_add_u32 s66, s66, 4352
    v_lshlrev_b32 v20, 2, v1
    v_add_u32 v20, s66, v20
    v_mov_b32 v21, 0
    ds_write_b32 v20, v21
    s_lshr_b32 s66, s13, 4
    s_and_b32 s67, s13, 15
    s_lshl_b32 s73, s66, 13
    s_lshl_b32 s74, s67, 8
    s_add_u32 s73, s73, s74
    s_mul_i32 s74, s10, 49152
    s_add_u32 s73, s73, s74
    s_add_u32 s68, s73, 4096
    s_bfe_u32 s66, s6, 0x10001
    s_mul_i32 s66, s66, 4096
    s_and_b32 s67, s6, 1
    s_lshl_b32 s67, s67, 7
    s_add_u32 s68, s68, s66
    s_add_u32 s68, s68, s67
    s_mov_b32 s96, 1
    s_cmp_eq_u32 s6, 0
    s_cbranch_scc1 L_a_sec0
    s_cmp_eq_u32 s6, 1
    s_cbranch_scc1 L_a_sec1
    s_cmp_eq_u32 s6, 2
    s_cbranch_scc1 L_q_sec0
    s_cmp_eq_u32 s6, 3
    s_cbranch_scc1 L_q_sec1
    s_cmp_eq_u32 s6, 4
    s_cbranch_scc1 L_q_sec2
L_a_drydone:
L_q_drydone:
    s_mov_b32 s96, 0
    s_barrier
    s_cmp_ge_u32 s9, 8
    s_cbranch_scc0 L_fo_q
    s_waitcnt vmcnt(17)
    v_lshlrev_b32 v236, 16, v236
    v_lshlrev_b32 v237, 16, v237
    v_lshlrev_b32 v238, 16, v238
    v_lshlrev_b32 v239, 16, v239
    v_mul_f32 v16, 0xbfb8aa3b, v236
    v_mul_f32 v17, 0xbfb8aa3b, v237
    v_mul_f32 v18, 0xbfb8aa3b, v238
    v_mul_f32 v19, 0xbfb8aa3b, v239
    v_exp_f32 v16, v16
    v_exp_f32 v17, v17
    v_exp_f32 v18, v18
    v_exp_f32 v19, v19
    v_add_f32 v16, 1.0, v16
    v_add_f32 v17, 1.0, v17
    v_add_f32 v18, 1.0, v18
    v_add_f32 v19, 1.0, v19
    v_rcp_f32 v16, v16
    v_rcp_f32 v17, v17
    v_rcp_f32 v18, v18
    v_rcp_f32 v19, v19
    v_mul_f32 v16, v236, v16
    v_mul_f32 v17, v237, v17
    v_mul_f32 v18, v238, v18
    v_mul_f32 v19, v239, v19
    v_cvt_pk_bf16_f32 v20, v16, v17
    v_cvt_pk_bf16_f32 v21, v18, v19
    ds_write_b64 v7, v[20:21]
    s_waitcnt vmcnt(9)
    v_perm_b32 v160, v68, v64, s46
    v_perm_b32 v161, v76, v72, s46
    v_perm_b32 v162, v84, v80, s46
    v_perm_b32 v163, v92, v88, s46
    v_perm_b32 v164, v68, v64, s47
    v_perm_b32 v165, v76, v72, s47
    v_perm_b32 v166, v84, v80, s47
    v_perm_b32 v167, v92, v88, s47
    v_perm_b32 v168, v69, v65, s46
    v_perm_b32 v169, v77, v73, s46
    v_perm_b32 v170, v85, v81, s46
    v_perm_b32 v171, v93, v89, s46
    v_perm_b32 v172, v69, v65, s47
    v_perm_b32 v173, v77, v73, s47
    v_perm_b32 v174, v85, v81, s47
    v_perm_b32 v175, v93, v89, s47
    v_perm_b32 v176, v70, v66, s46
    v_perm_b32 v177, v78, v74, s46
    v_perm_b32 v178, v86, v82, s46
    v_perm_b32 v179, v94, v90, s46
    v_perm_b32 v180, v70, v66, s47
    v_perm_b32 v181, v78, v74, s47
    v_perm_b32 v182, v86, v82, s47
    v_perm_b32 v183, v94, v90, s47
    v_perm_b32 v184, v71, v67, s46
    v_perm_b32 v185, v79, v75, s46
    v_perm_b32 v186, v87, v83, s46
    v_perm_b32 v187, v95, v91, s46
    v_perm_b32 v188, v71, v67, s47
    v_perm_b32 v189, v79, v75, s47
    v_perm_b32 v190, v87, v83, s47
    v_perm_b32 v191, v95, v91, s47
    s_waitcnt vmcnt(0)
    v_add_u32 v58, 1, v57
    v_and_b32 v12, 0xffff, v58
    v_and_b32 v13, 0xff, v58
    s_cmp_lg_u32 s96, 0
    s_cbranch_scc1 L_a_drydone
L_a_sec0:
    s_waitcnt lgkmcnt(0)
    ds_read_b128 v[200:203], v8 offset:0
    ds_read_b128 v[204:207], v9 offset:0
    ds_read_b128 v[208:211], v10 offset:0
    ds_read_b128 v[212:215], v11 offset:0
    s_waitcnt lgkmcnt(3)
    v_mfma_f32_16x16x32_bf16 v[192:195], v[160:163], v[200:203], 0
    v_mfma_f32_16x16x32_bf16 v[196:199], v[176:179], v[200:203], 0
    s_waitcnt lgkmcnt(2)
    v_mfma_f32_16x16x32_bf16 v[192:195], v[164:167], v[204:207], v[192:195]
    v_mfma_f32_16x16x32_bf16 v[196:199], v[180:183], v[204:207], v[196:199]
    s_waitcnt lgkmcnt(1)
    v_mfma_f32_16x16x32_bf16 v[192:195], v[168:171], v[208:211], v[192:195]
    v_mfma_f32_16x16x32_bf16 v[196:199], v[184:187], v[208:211], v[196:199]
    s_waitcnt lgkmcnt(0)
    v_mfma_f32_16x16x32_bf16 v[192:195], v[172:175], v[212:215], v[192:195]
    v_mfma_f32_16x16x32_bf16 v[196:199], v[188:191], v[212:215], v[196:199]
    s_mov_b32 exec_lo, 0x33333333
    s_mov_b32 exec_hi, 0xcccccccc
    s_nop 4
    ds_write_b128 v48, v[192:195]
    ds_write_b128 v48, v[196:199] offset:1088
    s_mov_b64 exec, -1
    s_waitcnt lgkmcnt(0)
    s_cmp_lg_u32 s96, 0
    s_cbranch_scc1 L_a_drydone
    s_barrier
    s_cmp_ge_u32 s6, 4
    s_cbranch_scc1 L_epi_done_a
L_a_sec1:
    ds_read_b128 v[20:23], v49
    ds_read_b128 v[24:27], v49 offset:16
    s_waitcnt lgkmcnt(0)
    v_pk_add_f32 v[20:21], v[20:21], v[24:25]
    v_pk_add_f32 v[22:23], v[22:23], v[26:27]
    s_nop 0
    v_add_f32_dpp v20, v20, v20 quad_perm:[1,0,3,2] row_mask:0xf bank_mask:0xf
    v_add_f32_dpp v21, v21, v21 quad_perm:[1,0,3,2] row_mask:0xf bank_mask:0xf
    v_add_f32_dpp v22, v22, v22 quad_perm:[1,0,3,2] row_mask:0xf bank_mask:0xf
    v_add_f32_dpp v23, v23, v23 quad_perm:[1,0,3,2] row_mask:0xf bank_mask:0xf
    v_add_f32_dpp v20, v20, v20 quad_perm:[2,3,0,1] row_mask:0xf bank_mask:0xf
    v_add_f32_dpp v21, v21, v21 quad_perm:[2,3,0,1] row_mask:0xf bank_mask:0xf
    v_add_f32_dpp v22, v22, v22 quad_perm:[2,3,0,1] row_mask:0xf bank_mask:0xf
    v_add_f32_dpp v23, v23, v23 quad_perm:[2,3,0,1] row_mask:0xf bank_mask:0xf
    v_add_f32_dpp v20, v20, v20 row_half_mirror row_mask:0xf bank_mask:0xf
    v_add_f32_dpp v21, v21, v21 row_half_mirror row_mask:0xf bank_mask:0xf
    v_add_f32_dpp v22, v22, v22 row_half_mirror row_mask:0xf bank_mask:0xf
    v_add_f32_dpp v23, v23, v23 row_half_mirror row_mask:0xf bank_mask:0xf
    v_add_u32 v20, 0x80, v20
    v_add_u32 v21, 0x80, v21
    v_add_u32 v22, 0x80, v22
    v_add_u32 v23, 0x80, v23
    v_and_or_b32 v24, v20, s26, v13
    v_and_or_b32 v25, v21, s26, v13
    v_and_or_b32 v26, v22, s26, v13
    v_and_or_b32 v27, v23, s26, v13
    s_mov_b32 exec_lo, 0x01010101
    s_mov_b32 exec_hi, 0x01010101
    s_cmp_lg_u32 s96, 0
    s_cbranch_scc1 L_nd_1
    buffer_store_dwordx4 v[24:27], v50, s[48:51], s68 offen sc1
L_nd_1:
    s_mov_b64 exec, -1
L_epi_done_a:
    s_cmp_lg_u32 s96, 0
    s_cbranch_scc1 L_a_drydone
    s_barrier
    s_mov_b32 s64, 8192
    s_lshl_b32 s65, s12, 7
    s_mov_b32 s52, s22
    s_mov_b32 s53, s23
    s_mov_b32 s54, 8388608
    s_mov_b32 s55, 0x00020000
    v_lshrrev_b32 v16, 3, v1
    v_and_b32 v17, 3, v16
    v_lshlrev_b32 v17, 1, v17
    v_lshrrev_b32 v16, 2, v16
    v_lshlrev_b32 v16, 5, v16
    v_add_u32 v16, v16, v17
    s_lshl_b32 s66, s10, 9
    s_lshl_b32 s67, s6, 6
    s_add_u32 s66, s66, s67
    v_add_u32 v16, s66, v16
    v_mul_lo_u32 v14, v16, s64
    v_and_b32 v17, 7, v1
    v_lshlrev_b32 v17, 4, v17
    v_add_u32 v14, v14, v17
    v_bfe_u32 v16, v1, 4, 1
    v_and_b32 v17, 15, v1
    s_lshl_b32 s67, s6, 4
    v_add_u32 v17, s67, v17
    v_mul_u32_u24 v18, 2176, v16
    v_lshlrev_b32 v19, 3, v17
    v_add_u32 v61, v18, v19
    s_lshl_b32 s66, s10, 7
    v_add_u32 v17, s66, v17
    v_lshrrev_b32 v18, 3, v17
    v_lshlrev_b32 v18, 5, v18
    v_and_b32 v19, 7, v17
    v_add_u32 v18, v18, v19
    v_lshlrev_b32 v18, 1, v18
    v_lshlrev_b32 v19, 11, v16
    v_add_u32 v60, v18, v19
    s_mul_i32 s66, s64, 0
    s_add_u32 s66, s66, s65
    buffer_load_dwordx4 v[64:67], v14, s[52:55], s66 offen nt
    s_mul_i32 s66, s64, 8
    s_add_u32 s66, s66, s65
    buffer_load_dwordx4 v[68:71], v14, s[52:55], s66 offen nt
    s_mul_i32 s66, s64, 16
    s_add_u32 s66, s66, s65
    buffer_load_dwordx4 v[72:75], v14, s[52:55], s66 offen nt
    s_mul_i32 s66, s64, 24
    s_add_u32 s66, s66, s65
    buffer_load_dwordx4 v[76:79], v14, s[52:55], s66 offen nt
    s_mul_i32 s66, s64, 1
    s_add_u32 s66, s66, s65
    buffer_load_dwordx4 v[80:83], v14, s[52:55], s66 offen nt
    s_mul_i32 s66, s64, 9
    s_add_u32 s66, s66, s65
    buffer_load_dwordx4 v[84:87], v14, s[52:55], s66 offen nt
    s_mul_i32 s66, s64, 17
    s_add_u32 s66, s66, s65
    buffer_load_dwordx4 v[88:91], v14, s[52:55], s66 offen nt
    s_mul_i32 s66, s64, 25
    s_add_u32 s66, s66, s65
    buffer_load_dwordx4 v[92:95], v14, s[52:55], s66 offen nt
    v_mov_b32 v16, 0
    v_mov_b32 v17, 0
    v_lshlrev_b32 v18, 16, v216
    v_and_b32 v19, 0xffff0000, v216
    v_add_f32 v16, v16, v18
    v_fmac_f32 v17, v18, v18
    v_add_f32 v16, v16, v19
    v_fmac_f32 v17, v19, v19
    v_lshlrev_b32 v18, 16, v217
    v_and_b32 v19, 0xffff0000, v217
    v_add_f32 v16, v16, v18
    v_fmac_f32 v17, v18, v18
    v_add_f32 v16, v16, v19
    v_fmac_f32 v17, v19, v19
    v_lshlrev_b32 v18, 16, v218
    v_and_b32 v19, 0xffff0000, v218
    v_add_f32 v16, v16, v18
    v_fmac_f32 v17, v18, v18
    v_add_f32 v16, v16, v19
    v_fmac_f32 v17, v19, v19
    v_lshlrev_b32 v18, 16, v219
    v_and_b32 v19, 0xffff0000, v219
    v_add_f32 v16, v16, v18
    v_fmac_f32 v17, v18, v18
    v_add_f32 v16, v16, v19
    v_fmac_f32 v17, v19, v19
    v_lshlrev_b32 v18, 16, v220
    v_and_b32 v19, 0xffff0000, v220
    v_add_f32 v16, v16, v18
    v_fmac_f32 v17, v18, v18
    v_add_f32 v16, v16, v19
    v_fmac_f32 v17, v19, v19
    v_lshlrev_b32 v18, 16, v221
    v_and_b32 v19, 0xffff0000, v221
    v_add_f32 v16, v16, v18
    v_fmac_f32 v17, v18, v18
    v_add_f32 v16, v16, v19
    v_fmac_f32 v17, v19, v19
    v_lshlrev_b32 v18, 16, v222
    v_and_b32 v19, 0xffff0000, v222
    v_add_f32 v16, v16, v18
    v_fmac_f32 v17, v18, v18
    v_add_f32 v16, v16, v19
    v_fmac_f32 v17, v19, v19
    v_lshlrev_b32 v18, 16, v223
    v_and_b32 v19, 0xffff0000, v223
    v_add_f32 v16, v16, v18
    v_fmac_f32 v17, v18, v18
    v_add_f32 v16, v16, v19
    v_fmac_f32 v17, v19, v19
    v_lshlrev_b32 v18, 16, v224
    v_and_b32 v19, 0xffff0000, v224
    v_add_f32 v16, v16, v18
    v_fmac_f32 v17, v18, v18
    v_add_f32 v16, v16, v19
    v_fmac_f32 v17, v19, v19
    v_lshlrev_b32 v18, 16, v225
    v_and_b32 v19, 0xffff0000, v225
    v_add_f32 v16, v16, v18
    v_fmac_f32 v17, v18, v18
    v_add_f32 v16, v16, v19
    v_fmac_f32 v17, v19, v19
    v_lshlrev_b32 v18, 16, v226
    v_and_b32 v19, 0xffff0000, v226
    v_add_f32 v16, v16, v18
    v_fmac_f32 v17, v18, v18
    v_add_f32 v16, v16, v19
    v_fmac_f32 v17, v19, v19
    v_lshlrev_b32 v18, 16, v227
    v_and_b32 v19, 0xffff0000, v227
    v_add_f32 v16, v16, v18
    v_fmac_f32 v17, v18, v18
    v_add_f32 v16, v16, v19
    v_fmac_f32 v17, v19, v19
    v_lshlrev_b32 v18, 16, v228
    v_and_b32 v19, 0xffff0000, v228
    v_add_f32 v16, v16, v18
    v_fmac_f32 v17, v18, v18
    v_add_f32 v16, v16, v19
    v_fmac_f32 v17, v19, v19
    v_lshlrev_b32 v18, 16, v229
    v_and_b32 v19, 0xffff0000, v229
    v_add_f32 v16, v16, v18
    v_fmac_f32 v17, v18, v18
    v_add_f32 v16, v16, v19
    v_fmac_f32 v17, v19, v19
    v_lshlrev_b32 v18, 16, v230
    v_and_b32 v19, 0xffff0000, v230
    v_add_f32 v16, v16, v18
    v_fmac_f32 v17, v18, v18
    v_add_f32 v16, v16, v19
    v_fmac_f32 v17, v19, v19
    v_lshlrev_b32 v18, 16, v231
    v_and_b32 v19, 0xffff0000, v231
    v_add_f32 v16, v16, v18
    v_fmac_f32 v17, v18, v18
    v_add_f32 v16, v16, v19
    v_fmac_f32 v17, v19, v19
    s_nop 0
    v_add_f32_dpp v16, v16, v16 row_ror:1 row_mask:0xf bank_mask:0xf
    v_add_f32_dpp v17, v17, v17 row_ror:1 row_mask:0xf bank_mask:0xf
    s_nop 0
    v_add_f32_dpp v16, v16, v16 row_ror:2 row_mask:0xf bank_mask:0xf
    v_add_f32_dpp v17, v17, v17 row_ror:2 row_mask:0xf bank_mask:0xf
    s_nop 0
    v_add_f32_dpp v16, v16, v16 row_ror:4 row_mask:0xf bank_mask:0xf
    v_add_f32_dpp v17, v17, v17 row_ror:4 row_mask:0xf bank_mask:0xf
    s_nop 0
    v_add_f32_dpp v16, v16, v16 row_ror:8 row_mask:0xf bank_mask:0xf
    v_add_f32_dpp v17, v17, v17 row_ror:8 row_mask:0xf bank_mask:0xf
    v_mov_b32 v18, v16
    v_mov_b32 v19, v17
    s_nop 0
    v_permlane16_swap_b32 v16, v18
    v_permlane16_swap_b32 v17, v19
    v_add_f32 v16, v16, v18
    v_add_f32 v17, v17, v19
    v_mov_b32 v18, v16
    v_mov_b32 v19, v17
    s_nop 0
    v_permlane32_swap_b32 v16, v18
    v_permlane32_swap_b32 v17, v19
    v_bfe_u32 v20, v1, 4, 1
    v_cmp_eq_u32 vcc, 1, v20
    s_nop 1
    v_cndmask_b32 v16, v16, v18, vcc
    v_cndmask_b32 v17, v17, v19, vcc
    v_mul_f32 v38, 0x3a800000, v16
    v_mul_f32 v39, 0x3a800000, v17
    v_fma_f32 v39, -v38, v38, v39
    v_max_f32 v39, 0, v39
    v_cvt_pk_bf16_f32 v36, v38, v38
    v_and_b32 v36, 0xffff0000, v36
    v_cvt_pk_bf16_f32 v39, v39, v39
    v_and_b32 v39, 0xffff0000, v39
    v_add_f32 v39, 0x3727c5ac, v39
    v_cvt_pk_bf16_f32 v39, v39, v39
    v_and_b32 v39, 0xffff0000, v39
    v_sqrt_f32 v39, v39
    s_nop 0
    v_cvt_pk_bf16_f32 v39, v39, v39
    v_and_b32 v39, 0xffff0000, v39
    v_rcp_f32 v37, v39
    v_lshlrev_b32 v232, 16, v232
    v_sub_f32 v232, v232, v36
    v_lshlrev_b32 v233, 16, v233
    v_sub_f32 v233, v233, v36
    v_lshlrev_b32 v234, 16, v234
    v_sub_f32 v234, v234, v36
    v_lshlrev_b32 v235, 16, v235
    v_sub_f32 v235, v235, v36
    v_cvt_pk_bf16_f32 v38, v232, v233
    v_cvt_pk_bf16_f32 v39, v234, v235
    v_lshlrev_b32 v232, 16, v38
    v_and_b32 v233, 0xffff0000, v38
    v_lshlrev_b32 v234, 16, v39
    v_and_b32 v235, 0xffff0000, v39
    v_mul_f32 v232, v232, v37
    v_mul_f32 v233, v233, v37
    v_mul_f32 v234, v234, v37
    v_mul_f32 v235, v235, v37
    v_cvt_pk_bf16_f32 v38, v232, v233
    v_cvt_pk_bf16_f32 v39, v234, v235
    v_lshlrev_b32 v232, 16, v38
    v_and_b32 v233, 0xffff0000, v38
    v_lshlrev_b32 v234, 16, v39
    v_and_b32 v235, 0xffff0000, v39
    s_waitcnt vmcnt(0)
    v_perm_b32 v128, v68, v64, s46
    v_perm_b32 v129, v76, v72, s46
    v_perm_b32 v130, v84, v80, s46
    v_perm_b32 v131, v92, v88, s46
    v_perm_b32 v132, v68, v64, s47
    v_perm_b32 v133, v76, v72, s47
    v_perm_b32 v134, v84, v80, s47
    v_perm_b32 v135, v92, v88, s47
    v_perm_b32 v136, v69, v65, s46
    v_perm_b32 v137, v77, v73, s46
    v_perm_b32 v138, v85, v81, s46
    v_perm_b32 v139, v93, v89, s46
    v_perm_b32 v140, v69, v65, s47
    v_perm_b32 v141, v77, v73, s47
    v_perm_b32 v142, v85, v81, s47
    v_perm_b32 v143, v93, v89, s47
    v_perm_b32 v144, v70, v66, s46
    v_perm_b32 v145, v78, v74, s46
    v_perm_b32 v146, v86, v82, s46
    v_perm_b32 v147, v94, v90, s46
    v_perm_b32 v148, v70, v66, s47
    v_perm_b32 v149, v78, v74, s47
    v_perm_b32 v150, v86, v82, s47
    v_perm_b32 v151, v94, v90, s47
    v_perm_b32 v152, v71, v67, s46
    v_perm_b32 v153, v79, v75, s46
    v_perm_b32 v154, v87, v83, s46
    v_perm_b32 v155, v95, v91, s46
    v_perm_b32 v156, v71, v67, s47
    v_perm_b32 v157, v79, v75, s47
    v_perm_b32 v158, v87, v83, s47
    v_perm_b32 v159, v95, v91, s47
    s_branch L_q_ready
L_fo_q:
    s_waitcnt vmcnt(0)
    v_add_u32 v58, 1, v57
    v_and_b32 v12, 0xffff, v58
    v_and_b32 v13, 0xff, v58
    v_perm_b32 v128, v68, v64, s46
    v_perm_b32 v129, v76, v72, s46
    v_perm_b32 v130, v84, v80, s46
    v_perm_b32 v131, v92, v88, s46
    v_perm_b32 v132, v68, v64, s47
    v_perm_b32 v133, v76, v72, s47
    v_perm_b32 v134, v84, v80, s47
    v_perm_b32 v135, v92, v88, s47
    v_perm_b32 v136, v69, v65, s46
    v_perm_b32 v137, v77, v73, s46
    v_perm_b32 v138, v85, v81, s46
    v_perm_b32 v139, v93, v89, s46
    v_perm_b32 v140, v69, v65, s47
    v_perm_b32 v141, v77, v73, s47
    v_perm_b32 v142, v85, v81, s47
    v_perm_b32 v143, v93, v89, s47
    v_perm_b32 v144, v70, v66, s46
    v_perm_b32 v145, v78, v74, s46
    v_perm_b32 v146, v86, v82, s46
    v_perm_b32 v147, v94, v90, s46
    v_perm_b32 v148, v70, v66, s47
    v_perm_b32 v149, v78, v74, s47
    v_perm_b32 v150, v86, v82, s47
    v_perm_b32 v151, v94, v90, s47
    v_perm_b32 v152, v71, v67, s46
    v_perm_b32 v153, v79, v75, s46
    v_perm_b32 v154, v87, v83, s46
    v_perm_b32 v155, v95, v91, s46
    v_perm_b32 v156, v71, v67, s47
    v_perm_b32 v157, v79, v75, s47
    v_perm_b32 v158, v87, v83, s47
    v_perm_b32 v159, v95, v91, s47
    v_mov_b32 v16, 0
    v_mov_b32 v17, 0
    v_lshlrev_b32 v18, 16, v216
    v_and_b32 v19, 0xffff0000, v216
    v_add_f32 v16, v16, v18
    v_fmac_f32 v17, v18, v18
    v_add_f32 v16, v16, v19
    v_fmac_f32 v17, v19, v19
    v_lshlrev_b32 v18, 16, v217
    v_and_b32 v19, 0xffff0000, v217
    v_add_f32 v16, v16, v18
    v_fmac_f32 v17, v18, v18
    v_add_f32 v16, v16, v19
    v_fmac_f32 v17, v19, v19
    v_lshlrev_b32 v18, 16, v218
    v_and_b32 v19, 0xffff0000, v218
    v_add_f32 v16, v16, v18
    v_fmac_f32 v17, v18, v18
    v_add_f32 v16, v16, v19
    v_fmac_f32 v17, v19, v19
    v_lshlrev_b32 v18, 16, v219
    v_and_b32 v19, 0xffff0000, v219
    v_add_f32 v16, v16, v18
    v_fmac_f32 v17, v18, v18
    v_add_f32 v16, v16, v19
    v_fmac_f32 v17, v19, v19
    v_lshlrev_b32 v18, 16, v220
    v_and_b32 v19, 0xffff0000, v220
    v_add_f32 v16, v16, v18
    v_fmac_f32 v17, v18, v18
    v_add_f32 v16, v16, v19
    v_fmac_f32 v17, v19, v19
    v_lshlrev_b32 v18, 16, v221
    v_and_b32 v19, 0xffff0000, v221
    v_add_f32 v16, v16, v18
    v_fmac_f32 v17, v18, v18
    v_add_f32 v16, v16, v19
    v_fmac_f32 v17, v19, v19
    v_lshlrev_b32 v18, 16, v222
    v_and_b32 v19, 0xffff0000, v222
    v_add_f32 v16, v16, v18
    v_fmac_f32 v17, v18, v18
    v_add_f32 v16, v16, v19
    v_fmac_f32 v17, v19, v19
    v_lshlrev_b32 v18, 16, v223
    v_and_b32 v19, 0xffff0000, v223
    v_add_f32 v16, v16, v18
    v_fmac_f32 v17, v18, v18
    v_add_f32 v16, v16, v19
    v_fmac_f32 v17, v19, v19
    v_lshlrev_b32 v18, 16, v224
    v_and_b32 v19, 0xffff0000, v224
    v_add_f32 v16, v16, v18
    v_fmac_f32 v17, v18, v18
    v_add_f32 v16, v16, v19
    v_fmac_f32 v17, v19, v19
    v_lshlrev_b32 v18, 16, v225
    v_and_b32 v19, 0xffff0000, v225
    v_add_f32 v16, v16, v18
    v_fmac_f32 v17, v18, v18
    v_add_f32 v16, v16, v19
    v_fmac_f32 v17, v19, v19
    v_lshlrev_b32 v18, 16, v226
    v_and_b32 v19, 0xffff0000, v226
    v_add_f32 v16, v16, v18
    v_fmac_f32 v17, v18, v18
    v_add_f32 v16, v16, v19
    v_fmac_f32 v17, v19, v19
    v_lshlrev_b32 v18, 16, v227
    v_and_b32 v19, 0xffff0000, v227
    v_add_f32 v16, v16, v18
    v_fmac_f32 v17, v18, v18
    v_add_f32 v16, v16, v19
    v_fmac_f32 v17, v19, v19
    v_lshlrev_b32 v18, 16, v228
    v_and_b32 v19, 0xffff0000, v228
    v_add_f32 v16, v16, v18
    v_fmac_f32 v17, v18, v18
    v_add_f32 v16, v16, v19
    v_fmac_f32 v17, v19, v19
    v_lshlrev_b32 v18, 16, v229
    v_and_b32 v19, 0xffff0000, v229
    v_add_f32 v16, v16, v18
    v_fmac_f32 v17, v18, v18
    v_add_f32 v16, v16, v19
    v_fmac_f32 v17, v19, v19
    v_lshlrev_b32 v18, 16, v230
    v_and_b32 v19, 0xffff0000, v230
    v_add_f32 v16, v16, v18
    v_fmac_f32 v17, v18, v18
    v_add_f32 v16, v16, v19
    v_fmac_f32 v17, v19, v19
    v_lshlrev_b32 v18, 16, v231
    v_and_b32 v19, 0xffff0000, v231
    v_add_f32 v16, v16, v18
    v_fmac_f32 v17, v18, v18
    v_add_f32 v16, v16, v19
    v_fmac_f32 v17, v19, v19
    s_nop 0
    v_add_f32_dpp v16, v16, v16 row_ror:1 row_mask:0xf bank_mask:0xf
    v_add_f32_dpp v17, v17, v17 row_ror:1 row_mask:0xf bank_mask:0xf
    s_nop 0
    v_add_f32_dpp v16, v16, v16 row_ror:2 row_mask:0xf bank_mask:0xf
    v_add_f32_dpp v17, v17, v17 row_ror:2 row_mask:0xf bank_mask:0xf
    s_nop 0
    v_add_f32_dpp v16, v16, v16 row_ror:4 row_mask:0xf bank_mask:0xf
    v_add_f32_dpp v17, v17, v17 row_ror:4 row_mask:0xf bank_mask:0xf
    s_nop 0
    v_add_f32_dpp v16, v16, v16 row_ror:8 row_mask:0xf bank_mask:0xf
    v_add_f32_dpp v17, v17, v17 row_ror:8 row_mask:0xf bank_mask:0xf
    v_mov_b32 v18, v16
    v_mov_b32 v19, v17
    s_nop 0
    v_permlane16_swap_b32 v16, v18
    v_permlane16_swap_b32 v17, v19
    v_add_f32 v16, v16, v18
    v_add_f32 v17, v17, v19
    v_mov_b32 v18, v16
    v_mov_b32 v19, v17
    s_nop 0
    v_permlane32_swap_b32 v16, v18
    v_permlane32_swap_b32 v17, v19
    v_bfe_u32 v20, v1, 4, 1
    v_cmp_eq_u32 vcc, 1, v20
    s_nop 1
    v_cndmask_b32 v16, v16, v18, vcc
    v_cndmask_b32 v17, v17, v19, vcc
    v_mul_f32 v38, 0x3a800000, v16
    v_mul_f32 v39, 0x3a800000, v17
    v_fma_f32 v39, -v38, v38, v39
    v_max_f32 v39, 0, v39
    v_cvt_pk_bf16_f32 v36, v38, v38
    v_and_b32 v36, 0xffff0000, v36
    v_cvt_pk_bf16_f32 v39, v39, v39
    v_and_b32 v39, 0xffff0000, v39
    v_add_f32 v39, 0x3727c5ac, v39
    v_cvt_pk_bf16_f32 v39, v39, v39
    v_and_b32 v39, 0xffff0000, v39
    v_sqrt_f32 v39, v39
    s_nop 0
    v_cvt_pk_bf16_f32 v39, v39, v39
    v_and_b32 v39, 0xffff0000, v39
    v_rcp_f32 v37, v39
    v_lshlrev_b32 v232, 16, v232
    v_sub_f32 v232, v232, v36
    v_lshlrev_b32 v233, 16, v233
    v_sub_f32 v233, v233, v36
    v_lshlrev_b32 v234, 16, v234
    v_sub_f32 v234, v234, v36
    v_lshlrev_b32 v235, 16, v235
    v_sub_f32 v235, v235, v36
    v_cvt_pk_bf16_f32 v38, v232, v233
    v_cvt_pk_bf16_f32 v39, v234, v235
    v_lshlrev_b32 v232, 16, v38
    v_and_b32 v233, 0xffff0000, v38
    v_lshlrev_b32 v234, 16, v39
    v_and_b32 v235, 0xffff0000, v39
    v_mul_f32 v232, v232, v37
    v_mul_f32 v233, v233, v37
    v_mul_f32 v234, v234, v37
    v_mul_f32 v235, v235, v37
    v_cvt_pk_bf16_f32 v38, v232, v233
    v_cvt_pk_bf16_f32 v39, v234, v235
    v_lshlrev_b32 v232, 16, v38
    v_and_b32 v233, 0xffff0000, v38
    v_lshlrev_b32 v234, 16, v39
    v_and_b32 v235, 0xffff0000, v39
    s_cmp_lt_u32 s9, 4
    s_cbranch_scc0 L_q_ready
    s_cmp_lg_u32 s6, 0
    s_cbranch_scc1 L_q_ready
    s_getreg_b32 s67, hwreg(HW_REG_XCC_ID)
    s_and_b32 s67, s67, 15
    s_lshl_b32 s66, s67, 8
    v_or_b32 v16, s66, v13
    v_mov_b32 v17, 0
    s_lshl_b32 s66, s7, 7
    s_lshl_b32 s67, s9, 2
    s_add_u32 s66, s66, s67
    s_add_u32 s66, s66, 106560
    s_mov_b32 exec_lo, 1
    s_mov_b32 exec_hi, 0
    buffer_store_dword v16, v17, s[48:51], s66 offen sc1
    s_mov_b64 exec, -1
L_q_ready:
    s_lshl_b32 s73, s12, 8
    s_lshl_b32 s74, s10, 15
    s_add_u32 s73, s73, s74
    s_add_u32 s68, s73, 1114112
    s_bfe_u32 s66, s6, 0x10001
    s_mul_i32 s66, s66, 16384
    s_and_b32 s67, s6, 1
    s_lshl_b32 s67, s67, 7
    s_add_u32 s68, s68, s66
    s_add_u32 s68, s68, s67
L_q_sec0:
    s_mov_b32 s66, 4096
    s_mov_b32 s67, 53248
    s_mov_b32 s73, 12288
    s_mov_b32 s74, 61440
    s_mov_b32 s70, 200000
L_poll_2:
    s_cmp_lg_u32 s96, 0
    s_cbranch_scc1 L_psk_4
    buffer_load_dwordx4 v[20:23], v4, s[48:51], s66 offen sc1
    buffer_load_dwordx4 v[24:27], v4, s[48:51], s67 offen sc1
    buffer_load_dwordx4 v[28:31], v4, s[48:51], s73 offen sc1
    buffer_load_dwordx4 v[32:35], v4, s[48:51], s74 offen sc1
    s_waitcnt vmcnt(0)
L_psk_4:
    v_xor_b32 v20, v13, v20
    v_xor_b32 v21, v13, v21
    v_or_b32 v16, v20, v21
    v_xor_b32 v22, v13, v22
    v_xor_b32 v23, v13, v23
    v_or3_b32 v16, v16, v22, v23
    v_xor_b32 v24, v13, v24
    v_xor_b32 v25, v13, v25
    v_or3_b32 v16, v16, v24, v25
    v_xor_b32 v26, v13, v26
    v_xor_b32 v27, v13, v27
    v_or3_b32 v16, v16, v26, v27
    v_xor_b32 v28, v13, v28
    v_xor_b32 v29, v13, v29
    v_or3_b32 v16, v16, v28, v29
    v_xor_b32 v30, v13, v30
    v_xor_b32 v31, v13, v31
    v_or3_b32 v16, v16, v30, v31
    v_xor_b32 v32, v13, v32
    v_xor_b32 v33, v13, v33
    v_or3_b32 v16, v16, v32, v33
    v_xor_b32 v34, v13, v34
    v_xor_b32 v35, v13, v35
    v_or3_b32 v16, v16, v34, v35
    v_and_b32 v16, 0xff, v16
    v_cmp_ne_u32 vcc, 0, v16
    s_nop 1
    s_cbranch_vccz L_pdone_3
    s_cmp_lg_u32 s96, 0
    s_cbranch_scc1 L_pdone_3
    s_sub_u32 s70, s70, 1
    s_cmp_lg_u32 s70, 0
    s_cbranch_scc1 L_poll_2
L_pdone_3:
    v_pk_add_f32 v[20:21], v[20:21], v[24:25]
    v_pk_add_f32 v[22:23], v[22:23], v[26:27]
    v_pk_add_f32 v[24:25], v[28:29], v[32:33]
    v_pk_add_f32 v[26:27], v[30:31], v[34:35]
    v_cvt_pk_bf16_f32 v28, v20, v21
    v_cvt_pk_bf16_f32 v29, v22, v23
    v_lshlrev_b32 v20, 16, v28
    v_and_b32 v21, 0xffff0000, v28
    v_lshlrev_b32 v22, 16, v29
    v_and_b32 v23, 0xffff0000, v29
    v_cvt_pk_bf16_f32 v30, v24, v25
    v_cvt_pk_bf16_f32 v31, v26, v27
    v_lshlrev_b32 v24, 16, v30
    v_and_b32 v25, 0xffff0000, v30
    v_lshlrev_b32 v26, 16, v31
    v_and_b32 v27, 0xffff0000, v31
    v_pk_add_f32 v[24:25], v[24:25], 1.0 op_sel_hi:[1,0]
    v_pk_add_f32 v[26:27], v[26:27], 1.0 op_sel_hi:[1,0]
    v_cvt_pk_bf16_f32 v28, v24, v25
    v_cvt_pk_bf16_f32 v29, v26, v27
    v_lshlrev_b32 v24, 16, v28
    v_and_b32 v25, 0xffff0000, v28
    v_lshlrev_b32 v26, 16, v29
    v_and_b32 v27, 0xffff0000, v29
    v_pk_mul_f32 v[24:25], v[232:233], v[24:25]
    v_pk_mul_f32 v[26:27], v[234:235], v[26:27]
    v_cvt_pk_bf16_f32 v28, v24, v25
    v_cvt_pk_bf16_f32 v29, v26, v27
    v_lshlrev_b32 v24, 16, v28
    v_and_b32 v25, 0xffff0000, v28
    v_lshlrev_b32 v26, 16, v29
    v_and_b32 v27, 0xffff0000, v29
    v_pk_add_f32 v[24:25], v[24:25], v[20:21]
    v_pk_add_f32 v[26:27], v[26:27], v[22:23]
    v_cvt_pk_bf16_f32 v28, v24, v25
    v_cvt_pk_bf16_f32 v29, v26, v27
    ds_write_b64 v7, v[28:29]
    s_cmp_lg_u32 s96, 0
    s_cbranch_scc1 L_q_drydone
L_q_sec1:
    s_waitcnt lgkmcnt(0)
    ds_read_b128 v[200:203], v8 offset:0
    ds_read_b128 v[204:207], v9 offset:0
    ds_read_b128 v[208:211], v10 offset:0
    ds_read_b128 v[212:215], v11 offset:0
    s_waitcnt lgkmcnt(3)
    v_mfma_f32_16x16x32_bf16 v[192:195], v[128:131], v[200:203], 0
    v_mfma_f32_16x16x32_bf16 v[196:199], v[144:147], v[200:203], 0
    s_waitcnt lgkmcnt(2)
    v_mfma_f32_16x16x32_bf16 v[192:195], v[132:135], v[204:207], v[192:195]
    v_mfma_f32_16x16x32_bf16 v[196:199], v[148:151], v[204:207], v[196:199]
    s_waitcnt lgkmcnt(1)
    v_mfma_f32_16x16x32_bf16 v[192:195], v[136:139], v[208:211], v[192:195]
    v_mfma_f32_16x16x32_bf16 v[196:199], v[152:155], v[208:211], v[196:199]
    s_waitcnt lgkmcnt(0)
    v_mfma_f32_16x16x32_bf16 v[192:195], v[140:143], v[212:215], v[192:195]
    v_mfma_f32_16x16x32_bf16 v[196:199], v[156:159], v[212:215], v[196:199]
    s_mov_b32 exec_lo, 0x33333333
    s_mov_b32 exec_hi, 0xcccccccc
    s_nop 4
    ds_write_b128 v48, v[192:195]
    ds_write_b128 v48, v[196:199] offset:1088
    s_mov_b64 exec, -1
    s_waitcnt lgkmcnt(0)
    s_cmp_lg_u32 s96, 0
    s_cbranch_scc1 L_q_drydone
    s_barrier
    s_cmp_ge_u32 s6, 4
    s_cbranch_scc1 L_epi_done_q
L_q_sec2:
    ds_read_b128 v[20:23], v49
    ds_read_b128 v[24:27], v49 offset:16
    s_waitcnt lgkmcnt(0)
    v_pk_add_f32 v[20:21], v[20:21], v[24:25]
    v_pk_add_f32 v[22:23], v[22:23], v[26:27]
    s_nop 0
    v_add_f32_dpp v20, v20, v20 quad_perm:[1,0,3,2] row_mask:0xf bank_mask:0xf
    v_add_f32_dpp v21, v21, v21 quad_perm:[1,0,3,2] row_mask:0xf bank_mask:0xf
    v_add_f32_dpp v22, v22, v22 quad_perm:[1,0,3,2] row_mask:0xf bank_mask:0xf
    v_add_f32_dpp v23, v23, v23 quad_perm:[1,0,3,2] row_mask:0xf bank_mask:0xf
    v_add_f32_dpp v20, v20, v20 quad_perm:[2,3,0,1] row_mask:0xf bank_mask:0xf
    v_add_f32_dpp v21, v21, v21 quad_perm:[2,3,0,1] row_mask:0xf bank_mask:0xf
    v_add_f32_dpp v22, v22, v22 quad_perm:[2,3,0,1] row_mask:0xf bank_mask:0xf
    v_add_f32_dpp v23, v23, v23 quad_perm:[2,3,0,1] row_mask:0xf bank_mask:0xf
    v_add_f32_dpp v20, v20, v20 row_half_mirror row_mask:0xf bank_mask:0xf
    v_add_f32_dpp v21, v21, v21 row_half_mirror row_mask:0xf bank_mask:0xf
    v_add_f32_dpp v22, v22, v22 row_half_mirror row_mask:0xf bank_mask:0xf
    v_add_f32_dpp v23, v23, v23 row_half_mirror row_mask:0xf bank_mask:0xf
    v_add_u32 v20, 0x80, v20
    v_add_u32 v21, 0x80, v21
    v_add_u32 v22, 0x80, v22
    v_add_u32 v23, 0x80, v23
    v_and_or_b32 v24, v20, s26, v13
    v_and_or_b32 v25, v21, s26, v13
    v_and_or_b32 v26, v22, s26, v13
    v_and_or_b32 v27, v23, s26, v13
    s_mov_b32 exec_lo, 0x01010101
    s_mov_b32 exec_hi, 0x01010101
    s_cmp_lg_u32 s96, 0
    s_cbranch_scc1 L_nd_5
    buffer_store_dwordx4 v[24:27], v50, s[48:51], s68 offen sc1
L_nd_5:
    s_mov_b64 exec, -1
L_epi_done_q:
    s_cmp_lg_u32 s96, 0
    s_cbranch_scc1 L_q_drydone
    s_barrier
    v_lshrrev_b32 v16, 3, v1
    v_and_b32 v17, 3, v16
    v_lshlrev_b32 v17, 1, v17
    v_lshrrev_b32 v16, 2, v16
    v_lshlrev_b32 v16, 5, v16
    v_add_u32 v16, v16, v17
    s_lshl_b32 s66, s6, 7
    v_add_u32 v2, s66, v16
    v_and_b32 v3, 7, v1
    v_lshlrev_b32 v3, 4, v3
    s_cmp_ge_u32 s9, 8
    s_cbranch_scc1 L_JOB_Upre
    s_mov_b32 s52, s24
    s_mov_b32 s53, s25
    s_mov_b32 s54, 8388608
    s_mov_b32 s55, 0x00020000
    s_lshl_b32 s11, s7, 3
    s_add_u32 s11, s11, s9
    s_mov_b32 s64, 2048
    s_lshr_b32 s73, s11, 4
    s_and_b32 s74, s11, 15
    s_lshl_b32 s65, s73, 21
    s_lshl_b32 s75, s74, 7
    s_add_u32 s65, s65, s75
    v_lshlrev_b32 v14, 11, v2
    v_add_u32 v14, v14, v3
    s_mul_i32 s66, s64, 0
    s_add_u32 s66, s66, s65
    buffer_load_dwordx4 v[64:67], v14, s[52:55], s66 offen nt
    s_mul_i32 s66, s64, 8
    s_add_u32 s66, s66, s65
    buffer_load_dwordx4 v[68:71], v14, s[52:55], s66 offen nt
    s_mul_i32 s66, s64, 16
    s_add_u32 s66, s66, s65
    buffer_load_dwordx4 v[72:75], v14, s[52:55], s66 offen nt
    s_mul_i32 s66, s64, 24
    s_add_u32 s66, s66, s65
    buffer_load_dwordx4 v[76:79], v14, s[52:55], s66 offen nt
    s_mul_i32 s66, s64, 1
    s_add_u32 s66, s66, s65
    buffer_load_dwordx4 v[80:83], v14, s[52:55], s66 offen nt
    s_mul_i32 s66, s64, 9
    s_add_u32 s66, s66, s65
    buffer_load_dwordx4 v[84:87], v14, s[52:55], s66 offen nt
    s_mul_i32 s66, s64, 17
    s_add_u32 s66, s66, s65
    buffer_load_dwordx4 v[88:91], v14, s[52:55], s66 offen nt
    s_mul_i32 s66, s64, 25
    s_add_u32 s66, s66, s65
    buffer_load_dwordx4 v[92:95], v14, s[52:55], s66 offen nt
    s_mul_i32 s66, s64, 64
    s_add_u32 s66, s66, s65
    buffer_load_dwordx4 v[96:99], v14, s[52:55], s66 offen nt
    s_mul_i32 s66, s64, 72
    s_add_u32 s66, s66, s65
    buffer_load_dwordx4 v[100:103], v14, s[52:55], s66 offen nt
    s_mul_i32 s66, s64, 80
    s_add_u32 s66, s66, s65
    buffer_load_dwordx4 v[104:107], v14, s[52:55], s66 offen nt
    s_mul_i32 s66, s64, 88
    s_add_u32 s66, s66, s65
    buffer_load_dwordx4 v[108:111], v14, s[52:55], s66 offen nt
    s_mul_i32 s66, s64, 65
    s_add_u32 s66, s66, s65
    buffer_load_dwordx4 v[112:115], v14, s[52:55], s66 offen nt
    s_mul_i32 s66, s64, 73
    s_add_u32 s66, s66, s65
    buffer_load_dwordx4 v[116:119], v14, s[52:55], s66 offen nt
    s_mul_i32 s66, s64, 81
    s_add_u32 s66, s66, s65
    buffer_load_dwordx4 v[120:123], v14, s[52:55], s66 offen nt
    s_mul_i32 s66, s64, 89
    s_add_u32 s66, s66, s65
    buffer_load_dwordx4 v[124:127], v14, s[52:55], s66 offen nt
    v_lshrrev_b32 v16, 5, v1
    v_and_b32 v17, 31, v1
    s_lshl_b32 s66, s6, 5
    v_add_u32 v17, s66, v17
    v_lshrrev_b32 v18, 3, v17
    v_lshlrev_b32 v18, 5, v18
    v_and_b32 v19, 7, v17
    v_add_u32 v18, v18, v19
    v_lshlrev_b32 v18, 1, v18
    v_lshlrev_b32 v19, 11, v16
    v_add_u32 v6, v18, v19
    v_lshlrev_b32 v18, 4, v17
    v_lshlrev_b32 v19, 12, v16
    v_add_u32 v4, v19, v18
    v_lshlrev_b32 v19, 14, v16
    v_add_u32 v5, v19, v18
    v_mul_u32_u24 v18, 2176, v16
    v_lshlrev_b32 v19, 3, v17
    v_add_u32 v7, v18, v19
    v_and_b32 v16, 1, v1
    v_mul_u32_u24 v18, 2176, v16
    v_lshrrev_b32 v19, 4, v1
    v_lshlrev_b32 v19, 5, v19
    v_add_u32 v18, v18, v19
    v_bfe_u32 v19, v1, 1, 1
    v_lshlrev_b32 v19, 4, v19
    v_add_u32 v18, v18, v19
    s_lshl_b32 s66, s6, 8
    v_add_u32 v18, s66, v18
    s_lshl_b32 s66, s6, 8
    s_add_u32 s66, s66, 4352
    v_mov_b32 v19, s66
    v_bfe_u32 v20, v1, 2, 2
    v_cmp_eq_u32 vcc, 0, v20
    s_nop 1
    v_cndmask_b32 v8, v19, v18, vcc
    v_cmp_eq_u32 vcc, 1, v20
    s_nop 1
    v_cndmask_b32 v9, v19, v18, vcc
    v_cmp_eq_u32 vcc, 2, v20
    s_nop 1
    v_cndmask_b32 v10, v19, v18, vcc
    v_cmp_eq_u32 vcc, 3, v20
    s_nop 1
    v_cndmask_b32 v11, v19, v18, vcc
    s_lshr_b32 s73, s11, 4
    s_and_b32 s74, s11, 15
    s_lshl_b32 s69, s73, 12
    s_add_u32 s69, s69, 655360
    s_lshl_b32 s68, s73, 13
    s_lshl_b32 s74, s74, 8
    s_add_u32 s68, s68, s74
    s_add_u32 s68, s68, 688128
    s_bfe_u32 s66, s6, 0x10001
    s_mul_i32 s66, s66, 4096
    s_and_b32 s67, s6, 1
    s_lshl_b32 s67, s67, 7
    s_add_u32 s68, s68, s66
    s_add_u32 s68, s68, s67
    s_mov_b32 s96, 1
    s_cmp_eq_u32 s6, 0
    s_cbranch_scc1 L_o_sec0
    s_cmp_eq_u32 s6, 1
    s_cbranch_scc1 L_o_sec1
    s_cmp_eq_u32 s6, 2
    s_cbranch_scc1 L_o_sec2
    s_branch L_o_drydone
L_o_real:
    s_waitcnt vmcnt(8)
    v_perm_b32 v128, v68, v64, s46
    v_perm_b32 v129, v76, v72, s46
    v_perm_b32 v130, v84, v80, s46
    v_perm_b32 v131, v92, v88, s46
    v_perm_b32 v132, v68, v64, s47
    v_perm_b32 v133, v76, v72, s47
    v_perm_b32 v134, v84, v80, s47
    v_perm_b32 v135, v92, v88, s47
    v_perm_b32 v136, v69, v65, s46
    v_perm_b32 v137, v77, v73, s46
    v_perm_b32 v138, v85, v81, s46
    v_perm_b32 v139, v93, v89, s46
    v_perm_b32 v140, v69, v65, s47
    v_perm_b32 v141, v77, v73, s47
    v_perm_b32 v142, v85, v81, s47
    v_perm_b32 v143, v93, v89, s47
    v_perm_b32 v144, v70, v66, s46
    v_perm_b32 v145, v78, v74, s46
    v_perm_b32 v146, v86, v82, s46
    v_perm_b32 v147, v94, v90, s46
    v_perm_b32 v148, v70, v66, s47
    v_perm_b32 v149, v78, v74, s47
    v_perm_b32 v150, v86, v82, s47
    v_perm_b32 v151, v94, v90, s47
    v_perm_b32 v152, v71, v67, s46
    v_perm_b32 v153, v79, v75, s46
    v_perm_b32 v154, v87, v83, s46
    v_perm_b32 v155, v95, v91, s46
    v_perm_b32 v156, v71, v67, s47
    v_perm_b32 v157, v79, v75, s47
    v_perm_b32 v158, v87, v83, s47
    v_perm_b32 v159, v95, v91, s47
    s_waitcnt vmcnt(0)
    v_perm_b32 v160, v100, v96, s46
    v_perm_b32 v161, v108, v104, s46
    v_perm_b32 v162, v116, v112, s46
    v_perm_b32 v163, v124, v120, s46
    v_perm_b32 v164, v100, v96, s47
    v_perm_b32 v165, v108, v104, s47
    v_perm_b32 v166, v116, v112, s47
    v_perm_b32 v167, v124, v120, s47
    v_perm_b32 v168, v101, v97, s46
    v_perm_b32 v169, v109, v105, s46
    v_perm_b32 v170, v117, v113, s46
    v_perm_b32 v171, v125, v121, s46
    v_perm_b32 v172, v101, v97, s47
    v_perm_b32 v173, v109, v105, s47
    v_perm_b32 v174, v117, v113, s47
    v_perm_b32 v175, v125, v121, s47
    v_perm_b32 v176, v102, v98, s46
    v_perm_b32 v177, v110, v106, s46
    v_perm_b32 v178, v118, v114, s46
    v_perm_b32 v179, v126, v122, s46
    v_perm_b32 v180, v102, v98, s47
    v_perm_b32 v181, v110, v106, s47
    v_perm_b32 v182, v118, v114, s47
    v_perm_b32 v183, v126, v122, s47
    v_perm_b32 v184, v103, v99, s46
    v_perm_b32 v185, v111, v107, s46
    v_perm_b32 v186, v119, v115, s46
    v_perm_b32 v187, v127, v123, s46
    v_perm_b32 v188, v103, v99, s47
    v_perm_b32 v189, v111, v107, s47
    v_perm_b32 v190, v119, v115, s47
    v_perm_b32 v191, v127, v123, s47
L_o_sec0:
    s_mov_b32 s70, 200000
L_poll_6:
    s_cmp_lg_u32 s96, 0
    s_cbranch_scc1 L_psk_8
    buffer_load_dwordx4 v[20:23], v5, s[48:51], s69 offen sc1
    s_waitcnt vmcnt(0)
L_psk_8:
    v_xor_b32 v20, v12, v20
    v_xor_b32 v21, v12, v21
    v_or_b32 v16, v20, v21
    v_xor_b32 v22, v12, v22
    v_xor_b32 v23, v12, v23
    v_or3_b32 v16, v16, v22, v23
    v_and_b32 v16, 0xffff, v16
    v_cmp_ne_u32 vcc, 0, v16
    s_nop 1
    s_cbranch_vccz L_pdone_7
    s_cmp_lg_u32 s96, 0
    s_cbranch_scc1 L_pdone_7
    s_sub_u32 s70, s70, 1
    s_cmp_lg_u32 s70, 0
    s_cbranch_scc1 L_poll_6
L_pdone_7:
    v_perm_b32 v28, v21, v20, s47
    v_perm_b32 v29, v23, v22, s47
    ds_write_b64 v7, v[28:29]
    s_cmp_lg_u32 s96, 0
    s_cbranch_scc1 L_o_drydone
L_o_sec1:
    s_waitcnt lgkmcnt(0)
    ds_read_b128 v[200:203], v8 offset:0
    ds_read_b128 v[204:207], v9 offset:0
    ds_read_b128 v[208:211], v10 offset:0
    ds_read_b128 v[212:215], v11 offset:0
    ds_read_b128 v[216:219], v8 offset:128
    ds_read_b128 v[220:223], v9 offset:128
    ds_read_b128 v[224:227], v10 offset:128
    ds_read_b128 v[228:231], v11 offset:128
    s_waitcnt lgkmcnt(7)
    v_mfma_f32_16x16x32_bf16 v[192:195], v[128:131], v[200:203], 0
    v_mfma_f32_16x16x32_bf16 v[196:199], v[144:147], v[200:203], 0
    s_waitcnt lgkmcnt(6)
    v_mfma_f32_16x16x32_bf16 v[192:195], v[132:135], v[204:207], v[192:195]
    v_mfma_f32_16x16x32_bf16 v[196:199], v[148:151], v[204:207], v[196:199]
    s_waitcnt lgkmcnt(5)
    v_mfma_f32_16x16x32_bf16 v[192:195], v[136:139], v[208:211], v[192:195]
    v_mfma_f32_16x16x32_bf16 v[196:199], v[152:155], v[208:211], v[196:199]
    s_waitcnt lgkmcnt(4)
    v_mfma_f32_16x16x32_bf16 v[192:195], v[140:143], v[212:215], v[192:195]
    v_mfma_f32_16x16x32_bf16 v[196:199], v[156:159], v[212:215], v[196:199]
    s_waitcnt lgkmcnt(3)
    v_mfma_f32_16x16x32_bf16 v[192:195], v[160:163], v[216:219], v[192:195]
    v_mfma_f32_16x16x32_bf16 v[196:199], v[176:179], v[216:219], v[196:199]
    s_waitcnt lgkmcnt(2)
    v_mfma_f32_16x16x32_bf16 v[192:195], v[164:167], v[220:223], v[192:195]
    v_mfma_f32_16x16x32_bf16 v[196:199], v[180:183], v[220:223], v[196:199]
    s_waitcnt lgkmcnt(1)
    v_mfma_f32_16x16x32_bf16 v[192:195], v[168:171], v[224:227], v[192:195]
    v_mfma_f32_16x16x32_bf16 v[196:199], v[184:187], v[224:227], v[196:199]
    s_waitcnt lgkmcnt(0)
    v_mfma_f32_16x16x32_bf16 v[192:195], v[172:175], v[228:231], v[192:195]
    v_mfma_f32_16x16x32_bf16 v[196:199], v[188:191], v[228:231], v[196:199]
    s_mov_b32 exec_lo, 0x33333333
    s_mov_b32 exec_hi, 0xcccccccc
    s_nop 4
    ds_write_b128 v48, v[192:195]
    ds_write_b128 v48, v[196:199] offset:1088
    s_mov_b64 exec, -1
    s_waitcnt lgkmcnt(0)
    s_cmp_lg_u32 s96, 0
    s_cbranch_scc1 L_o_drydone
    s_barrier
    s_cmp_ge_u32 s6, 4
    s_cbranch_scc1 L_epi_done_o
L_o_sec2:
    ds_read_b128 v[20:23], v49
    ds_read_b128 v[24:27], v49 offset:16
    s_waitcnt lgkmcnt(0)
    v_pk_add_f32 v[20:21], v[20:21], v[24:25]
    v_pk_add_f32 v[22:23], v[22:23], v[26:27]
    s_nop 0
    v_add_f32_dpp v20, v20, v20 quad_perm:[1,0,3,2] row_mask:0xf bank_mask:0xf
    v_add_f32_dpp v21, v21, v21 quad_perm:[1,0,3,2] row_mask:0xf bank_mask:0xf
    v_add_f32_dpp v22, v22, v22 quad_perm:[1,0,3,2] row_mask:0xf bank_mask:0xf
    v_add_f32_dpp v23, v23, v23 quad_perm:[1,0,3,2] row_mask:0xf bank_mask:0xf
    v_add_f32_dpp v20, v20, v20 quad_perm:[2,3,0,1] row_mask:0xf bank_mask:0xf
    v_add_f32_dpp v21, v21, v21 quad_perm:[2,3,0,1] row_mask:0xf bank_mask:0xf
    v_add_f32_dpp v22, v22, v22 quad_perm:[2,3,0,1] row_mask:0xf bank_mask:0xf
    v_add_f32_dpp v23, v23, v23 quad_perm:[2,3,0,1] row_mask:0xf bank_mask:0xf
    v_add_f32_dpp v20, v20, v20 row_half_mirror row_mask:0xf bank_mask:0xf
    v_add_f32_dpp v21, v21, v21 row_half_mirror row_mask:0xf bank_mask:0xf
    v_add_f32_dpp v22, v22, v22 row_half_mirror row_mask:0xf bank_mask:0xf
    v_add_f32_dpp v23, v23, v23 row_half_mirror row_mask:0xf bank_mask:0xf
    v_and_or_b32 v24, v20, s26, v13
    v_and_or_b32 v25, v21, s26, v13
    v_and_or_b32 v26, v22, s26, v13
    v_and_or_b32 v27, v23, s26, v13
    s_mov_b32 exec_lo, 0x01010101
    s_mov_b32 exec_hi, 0x01010101
    s_cmp_lg_u32 s96, 0
    s_cbranch_scc1 L_nd_9
    buffer_store_dwordx4 v[24:27], v50, s[48:51], s68 offen sc1
L_nd_9:
    s_mov_b64 exec, -1
L_epi_done_o:
    s_cmp_eq_u32 s96, 0
    s_cbranch_scc1 L_o_out
L_o_drydone:
    s_mov_b32 s96, 0
    s_barrier
    s_branch L_o_real
L_o_out:
    s_barrier
    s_cmp_lt_u32 s9, 4
    s_cbranch_scc0 L_Fdone
L_FINAL:
    s_cmp_lg_u32 s6, 0
    s_cbranch_scc1 L_Fdone
    v_mov_b32 v30, v58
    s_lshl_b32 s66, s7, 2
    s_add_u32 s66, s66, s9
    v_lshrrev_b32 v16, 5, v1
    v_bfe_u32 v17, v1, 2, 3
    v_and_b32 v18, 3, v1
    v_lshlrev_b32 v19, 12, v16
    v_lshlrev_b32 v20, 4, v17
    v_add_u32 v19, v19, v20
    v_lshlrev_b32 v21, 13, v18
    v_add_u32 v21, v21, v19
    v_lshlrev_b32 v22, 11, v16
    v_lshlrev_b32 v23, 1, v17
    v_add_u32 v22, v22, v23
    v_lshlrev_b32 v24, 10, v18
    v_lshlrev_b32 v25, 9, v16
    v_add_u32 v24, v24, v25
    v_add_u32 v24, v24, v20
    s_lshl_b32 s65, s66, 6
    s_mov_b32 s56, s16
    s_mov_b32 s57, s17
    s_mov_b32 s58, 4096
    s_mov_b32 s59, 0x00020000
    s_mov_b32 s60, s34
    s_mov_b32 s61, s35
    s_mov_b32 s62, 2048
    s_mov_b32 s63, 0x00020000
    s_mov_b32 s52, s40
    s_mov_b32 s53, s41
    s_mov_b32 s54, 4096
    s_mov_b32 s55, 0x00020000
    buffer_load_ushort v40, v22, s[56:59], s65 offen offset:0
    buffer_load_ushort v41, v22, s[56:59], s65 offen offset:16
    buffer_load_ushort v42, v22, s[56:59], s65 offen offset:32
    buffer_load_ushort v43, v22, s[56:59], s65 offen offset:48
    buffer_load_ushort v44, v23, s[60:63], s65 offen offset:0
    buffer_load_ushort v45, v23, s[60:63], s65 offen offset:16
    buffer_load_ushort v46, v23, s[60:63], s65 offen offset:32
    buffer_load_ushort v47, v23, s[60:63], s65 offen offset:48
    buffer_load_ushort v48, v22, s[52:55], s65 offen
    s_lshl_b32 s73, s66, 7
    s_add_u32 s74, s73, 20480
    s_add_u32 s75, s73, 45056
    s_add_u32 s16, s74, 49152
    s_add_u32 s17, s75, 49152
    s_add_u32 s73, s73, 688128
    s_mov_b32 s70, 200000
L_poll_10:
    s_cmp_lg_u32 s96, 0
    s_cbranch_scc1 L_psk_12
    buffer_load_dwordx4 v[52:55], v19, s[48:51], s74 offen sc1
    buffer_load_dwordx4 v[56:59], v19, s[48:51], s75 offen sc1
    buffer_load_dwordx4 v[64:67], v19, s[48:51], s16 offen sc1
    buffer_load_dwordx4 v[68:71], v19, s[48:51], s17 offen sc1
    s_waitcnt vmcnt(0)
L_psk_12:
    v_xor_b32 v52, v13, v52
    v_xor_b32 v53, v13, v53
    v_or_b32 v26, v52, v53
    v_xor_b32 v54, v13, v54
    v_xor_b32 v55, v13, v55
    v_or3_b32 v26, v26, v54, v55
    v_xor_b32 v56, v13, v56
    v_xor_b32 v57, v13, v57
    v_or3_b32 v26, v26, v56, v57
    v_xor_b32 v58, v13, v58
    v_xor_b32 v59, v13, v59
    v_or3_b32 v26, v26, v58, v59
    v_xor_b32 v64, v13, v64
    v_xor_b32 v65, v13, v65
    v_or3_b32 v26, v26, v64, v65
    v_xor_b32 v66, v13, v66
    v_xor_b32 v67, v13, v67
    v_or3_b32 v26, v26, v66, v67
    v_xor_b32 v68, v13, v68
    v_xor_b32 v69, v13, v69
    v_or3_b32 v26, v26, v68, v69
    v_xor_b32 v70, v13, v70
    v_xor_b32 v71, v13, v71
    v_or3_b32 v26, v26, v70, v71
    v_and_b32 v26, 0xff, v26
    v_cmp_ne_u32 vcc, 0, v26
    s_nop 1
    s_cbranch_vccz L_pdone_11
    s_cmp_lg_u32 s96, 0
    s_cbranch_scc1 L_pdone_11
    s_sub_u32 s70, s70, 1
    s_cmp_lg_u32 s70, 0
    s_cbranch_scc1 L_poll_10
L_pdone_11:
    v_pk_add_f32 v[52:53], v[52:53], v[64:65]
    v_pk_add_f32 v[54:55], v[54:55], v[66:67]
    v_pk_add_f32 v[56:57], v[56:57], v[68:69]
    v_pk_add_f32 v[58:59], v[58:59], v[70:71]
    v_cvt_pk_bf16_f32 v28, v52, v53
    v_cvt_pk_bf16_f32 v29, v54, v55
    v_lshlrev_b32 v52, 16, v28
    v_and_b32 v53, 0xffff0000, v28
    v_lshlrev_b32 v54, 16, v29
    v_and_b32 v55, 0xffff0000, v29
    v_cvt_pk_bf16_f32 v28, v56, v57
    v_cvt_pk_bf16_f32 v29, v58, v59
    v_lshlrev_b32 v56, 16, v28
    v_and_b32 v57, 0xffff0000, v28
    v_lshlrev_b32 v58, 16, v29
    v_and_b32 v59, 0xffff0000, v29
    v_and_b32 v29, 31, v1
    v_min_u32 v29, 19, v29
    v_lshlrev_b32 v29, 2, v29
    s_lshl_b32 s18, s7, 7
    s_add_u32 s18, s18, 106496
    s_getreg_b32 s19, hwreg(HW_REG_XCC_ID)
    s_and_b32 s19, s19, 15
    s_mov_b32 s70, 200000
L_poll_13:
    s_cmp_lg_u32 s96, 0
    s_cbranch_scc1 L_psk_15
    buffer_load_dwordx4 v[60:63], v21, s[48:51], s73 offen sc1
    buffer_load_dwordx2 v[72:73], v29, s[48:51], s18 offen sc1
    s_waitcnt vmcnt(0)
L_psk_15:
    v_xor_b32 v60, v13, v60
    v_xor_b32 v61, v13, v61
    v_or_b32 v26, v60, v61
    v_xor_b32 v62, v13, v62
    v_xor_b32 v63, v13, v63
    v_or3_b32 v26, v26, v62, v63
    v_xor_b32 v72, v13, v72
    v_or3_b32 v26, v26, v72, v72
    v_and_b32 v26, 0xff, v26
    v_cmp_ne_u32 vcc, 0, v26
    s_nop 1
    s_cbranch_vccz L_pdone_14
    s_cmp_lg_u32 s96, 0
    s_cbranch_scc1 L_pdone_14
    s_sub_u32 s70, s70, 1
    s_cmp_lg_u32 s70, 0
    s_cbranch_scc1 L_poll_13
L_pdone_14:
    v_lshrrev_b32 v72, 8, v72
    v_cmp_ne_u32 vcc, s19, v72
    s_nop 1
    s_cmp_eq_u64 vcc, 0
    s_cselect_b32 s18, 1998848, 0
    v_add_f32_dpp v60, v60, v60 quad_perm:[1,0,3,2] row_mask:0xf bank_mask:0xf
    v_add_f32_dpp v61, v61, v61 quad_perm:[1,0,3,2] row_mask:0xf bank_mask:0xf
    v_add_f32_dpp v62, v62, v62 quad_perm:[1,0,3,2] row_mask:0xf bank_mask:0xf
    v_add_f32_dpp v63, v63, v63 quad_perm:[1,0,3,2] row_mask:0xf bank_mask:0xf
    v_add_f32_dpp v60, v60, v60 quad_perm:[2,3,0,1] row_mask:0xf bank_mask:0xf
    v_add_f32_dpp v61, v61, v61 quad_perm:[2,3,0,1] row_mask:0xf bank_mask:0xf
    v_add_f32_dpp v62, v62, v62 quad_perm:[2,3,0,1] row_mask:0xf bank_mask:0xf
    v_add_f32_dpp v63, v63, v63 quad_perm:[2,3,0,1] row_mask:0xf bank_mask:0xf
    v_cvt_pk_bf16_f32 v28, v60, v61
    v_cvt_pk_bf16_f32 v29, v62, v63
    v_lshlrev_b32 v60, 16, v28
    v_and_b32 v61, 0xffff0000, v28
    v_lshlrev_b32 v62, 16, v29
    v_and_b32 v63, 0xffff0000, v29
    v_lshlrev_b32 v40, 16, v40
    v_lshlrev_b32 v44, 16, v44
    v_mul_f32 v60, v52, v60
    v_lshlrev_b32 v41, 16, v41
    v_lshlrev_b32 v45, 16, v45
    v_mul_f32 v61, v53, v61
    v_lshlrev_b32 v42, 16, v42
    v_lshlrev_b32 v46, 16, v46
    v_mul_f32 v62, v54, v62
    v_lshlrev_b32 v43, 16, v43
    v_lshlrev_b32 v47, 16, v47
    v_mul_f32 v63, v55, v63
    v_cvt_pk_bf16_f32 v28, v60, v61
    v_cvt_pk_bf16_f32 v29, v62, v63
    v_lshlrev_b32 v60, 16, v28
    v_and_b32 v61, 0xffff0000, v28
    v_lshlrev_b32 v62, 16, v29
    v_and_b32 v63, 0xffff0000, v29
    v_add_f32 v60, v40, v60
    v_add_f32 v61, v41, v61
    v_add_f32 v62, v42, v62
    v_add_f32 v63, v43, v63
    v_cvt_pk_bf16_f32 v28, v60, v61
    v_cvt_pk_bf16_f32 v29, v62, v63
    v_lshlrev_b32 v60, 16, v28
    v_and_b32 v61, 0xffff0000, v28
    v_lshlrev_b32 v62, 16, v29
    v_and_b32 v63, 0xffff0000, v29
    s_lshl_b32 s73, s7, 14
    s_lshl_b32 s74, s9, 7
    s_add_u32 s73, s73, s74
    s_add_u32 s73, s73, 753664
    s_add_u32 s73, s73, s18
    s_add_u32 s74, s73, 4096
    s_add_u32 s75, s73, 8192
    s_add_u32 s66, s73, 12288
    s_mov_b32 s96, 1
L_FP2:
    s_mov_b32 s70, 200000
L_poll_16:
    s_cmp_lg_u32 s96, 0
    s_cbranch_scc1 L_psk_18
    buffer_load_dwordx4 v[64:67], v24, s[48:51], s73 offen sc1
    buffer_load_dwordx4 v[68:71], v24, s[48:51], s74 offen sc1
    buffer_load_dwordx4 v[72:75], v24, s[48:51], s75 offen sc1
    buffer_load_dwordx4 v[76:79], v24, s[48:51], s66 offen sc1
    s_waitcnt vmcnt(0)
L_psk_18:
    v_xor_b32 v64, v13, v64
    v_xor_b32 v65, v13, v65
    v_or_b32 v26, v64, v65
    v_xor_b32 v66, v13, v66
    v_xor_b32 v67, v13, v67
    v_or3_b32 v26, v26, v66, v67
    v_xor_b32 v68, v13, v68
    v_xor_b32 v69, v13, v69
    v_or3_b32 v26, v26, v68, v69
    v_xor_b32 v70, v13, v70
    v_xor_b32 v71, v13, v71
    v_or3_b32 v26, v26, v70, v71
    v_xor_b32 v72, v13, v72
    v_xor_b32 v73, v13, v73
    v_or3_b32 v26, v26, v72, v73
    v_xor_b32 v74, v13, v74
    v_xor_b32 v75, v13, v75
    v_or3_b32 v26, v26, v74, v75
    v_xor_b32 v76, v13, v76
    v_xor_b32 v77, v13, v77
    v_or3_b32 v26, v26, v76, v77
    v_xor_b32 v78, v13, v78
    v_xor_b32 v79, v13, v79
    v_or3_b32 v26, v26, v78, v79
    v_and_b32 v26, 0xff, v26
    v_cmp_ne_u32 vcc, 0, v26
    s_nop 1
    s_cbranch_vccz L_pdone_17
    s_cmp_lg_u32 s96, 0
    s_cbranch_scc1 L_pdone_17
    s_sub_u32 s70, s70, 1
    s_cmp_lg_u32 s70, 0
    s_cbranch_scc1 L_poll_16
L_pdone_17:
    v_pk_add_f32 v[64:65], v[64:65], v[68:69]
    v_pk_add_f32 v[66:67], v[66:67], v[70:71]
    v_pk_add_f32 v[72:73], v[72:73], v[76:77]
    v_pk_add_f32 v[74:75], v[74:75], v[78:79]
    v_pk_add_f32 v[64:65], v[64:65], v[72:73]
    v_pk_add_f32 v[66:67], v[66:67], v[74:75]
    s_nop 0
    v_add_f32_dpp v64, v64, v64 quad_perm:[1,0,3,2] row_mask:0xf bank_mask:0xf
    v_add_f32_dpp v65, v65, v65 quad_perm:[1,0,3,2] row_mask:0xf bank_mask:0xf
    v_add_f32_dpp v66, v66, v66 quad_perm:[1,0,3,2] row_mask:0xf bank_mask:0xf
    v_add_f32_dpp v67, v67, v67 quad_perm:[1,0,3,2] row_mask:0xf bank_mask:0xf
    v_add_f32_dpp v64, v64, v64 quad_perm:[2,3,0,1] row_mask:0xf bank_mask:0xf
    v_add_f32_dpp v65, v65, v65 quad_perm:[2,3,0,1] row_mask:0xf bank_mask:0xf
    v_add_f32_dpp v66, v66, v66 quad_perm:[2,3,0,1] row_mask:0xf bank_mask:0xf
    v_add_f32_dpp v67, v67, v67 quad_perm:[2,3,0,1] row_mask:0xf bank_mask:0xf
    v_pk_add_f32 v[64:65], v[64:65], v[44:45]
    v_pk_add_f32 v[66:67], v[66:67], v[46:47]
    v_pk_fma_f32 v[64:65], v[56:57], v[64:65], v[60:61]
    v_pk_fma_f32 v[66:67], v[58:59], v[66:67], v[62:63]
    v_cvt_pk_bf16_f32 v64, v64, v65
    v_cvt_pk_bf16_f32 v66, v66, v67
    s_mov_b32 exec_lo, 0x11111111
    s_mov_b32 exec_hi, 0x11111111
    s_cmp_lg_u32 s96, 0
    s_cbranch_scc1 L_nd_19
    buffer_store_short v64, v22, s[52:55], s65 offen
    buffer_store_short_d16_hi v64, v22, s[52:55], s65 offen offset:16
    buffer_store_short v66, v22, s[52:55], s65 offen offset:32
    buffer_store_short_d16_hi v66, v22, s[52:55], s65 offen offset:48
L_nd_19:
    s_mov_b64 exec, -1
    s_cmp_eq_u32 s96, 0
    s_cbranch_scc1 L_Fgen
    s_mov_b32 s96, 0
    s_branch L_FP2
L_Fgen:
    s_or_b32 s66, s7, s9
    s_cmp_lg_u32 s66, 0
    s_cbranch_scc1 L_Fdone
    v_mov_b32 v26, v30
    v_mov_b32 v27, 0
    s_mov_b32 exec_lo, 1
    s_mov_b32 exec_hi, 0
    buffer_store_dword v26, v27, s[48:51], 0 offen sc1
    s_mov_b64 exec, -1
    s_branch L_Fdone
L_JOB_Upre:
    s_sub_u32 s9, s9, 8
    s_cmp_lt_u32 s9, 7
    s_cbranch_scc0 L_Fdone
    s_mul_i32 s11, s7, 7
    s_add_u32 s11, s11, s9
L_JOB_U:
    s_mov_b32 s52, s28
    s_mov_b32 s53, s29
    s_mov_b32 s54, 7340032
    s_mov_b32 s55, 0x00020000
    s_mov_b32 s56, s16
    s_mov_b32 s57, s17
    s_mov_b32 s58, 4096
    s_mov_b32 s59, 0x00020000
    s_mov_b32 s60, s30
    s_mov_b32 s61, s31
    s_mov_b32 s62, 7168
    s_mov_b32 s63, 0x00020000
    s_mov_b32 s64, 7168
    s_lshl_b32 s65, s11, 7
    v_mul_u32_u24 v14, 7168, v2
    v_add_u32 v14, v14, v3
    s_and_b32 s66, s6, 1
    s_lshl_b32 s66, s66, 5
    v_lshrrev_b32 v16, 3, v1
    v_add_u32 v16, s66, v16
    v_lshlrev_b32 v15, 1, v16
    s_mul_i32 s66, s64, 0
    s_add_u32 s66, s66, s65
    buffer_load_dwordx4 v[64:67], v14, s[52:55], s66 offen nt
    s_mul_i32 s66, s64, 8
    s_add_u32 s66, s66, s65
    buffer_load_dwordx4 v[68:71], v14, s[52:55], s66 offen nt
    s_mul_i32 s66, s64, 16
    s_add_u32 s66, s66, s65
    buffer_load_dwordx4 v[72:75], v14, s[52:55], s66 offen nt
    s_mul_i32 s66, s64, 24
    s_add_u32 s66, s66, s65
    buffer_load_dwordx4 v[76:79], v14, s[52:55], s66 offen nt
    s_mul_i32 s66, s64, 1
    s_add_u32 s66, s66, s65
    buffer_load_dwordx4 v[80:83], v14, s[52:55], s66 offen nt
    s_mul_i32 s66, s64, 9
    s_add_u32 s66, s66, s65
    buffer_load_dwordx4 v[84:87], v14, s[52:55], s66 offen nt
    s_mul_i32 s66, s64, 17
    s_add_u32 s66, s66, s65
    buffer_load_dwordx4 v[88:91], v14, s[52:55], s66 offen nt
    s_mul_i32 s66, s64, 25
    s_add_u32 s66, s66, s65
    buffer_load_dwordx4 v[92:95], v14, s[52:55], s66 offen nt
    s_mul_i32 s66, s64, 64
    s_add_u32 s66, s66, s65
    buffer_load_dwordx4 v[96:99], v14, s[52:55], s66 offen nt
    s_mul_i32 s66, s64, 72
    s_add_u32 s66, s66, s65
    buffer_load_dwordx4 v[100:103], v14, s[52:55], s66 offen nt
    s_mul_i32 s66, s64, 80
    s_add_u32 s66, s66, s65
    buffer_load_dwordx4 v[104:107], v14, s[52:55], s66 offen nt
    s_mul_i32 s66, s64, 88
    s_add_u32 s66, s66, s65
    buffer_load_dwordx4 v[108:111], v14, s[52:55], s66 offen nt
    s_mul_i32 s66, s64, 65
    s_add_u32 s66, s66, s65
    buffer_load_dwordx4 v[112:115], v14, s[52:55], s66 offen nt
    s_mul_i32 s66, s64, 73
    s_add_u32 s66, s66, s65
    buffer_load_dwordx4 v[116:119], v14, s[52:55], s66 offen nt
    s_mul_i32 s66, s64, 81
    s_add_u32 s66, s66, s65
    buffer_load_dwordx4 v[120:123], v14, s[52:55], s66 offen nt
    s_mul_i32 s66, s64, 89
    s_add_u32 s66, s66, s65
    buffer_load_dwordx4 v[124:127], v14, s[52:55], s66 offen nt
    v_lshrrev_b32 v16, 5, v1
    v_and_b32 v17, 31, v1
    s_lshl_b32 s66, s6, 5
    v_add_u32 v17, s66, v17
    v_lshrrev_b32 v18, 3, v17
    v_lshlrev_b32 v18, 5, v18
    v_and_b32 v19, 7, v17
    v_add_u32 v18, v18, v19
    v_lshlrev_b32 v18, 1, v18
    v_lshlrev_b32 v19, 11, v16
    v_add_u32 v6, v18, v19
    v_lshlrev_b32 v18, 4, v17
    v_lshlrev_b32 v19, 12, v16
    v_add_u32 v4, v19, v18
    v_lshlrev_b32 v19, 14, v16
    v_add_u32 v5, v19, v18
    v_mul_u32_u24 v18, 2176, v16
    v_lshlrev_b32 v19, 3, v17
    v_add_u32 v7, v18, v19
    v_and_b32 v16, 1, v1
    v_mul_u32_u24 v18, 2176, v16
    v_lshrrev_b32 v19, 4, v1
    v_lshlrev_b32 v19, 5, v19
    v_add_u32 v18, v18, v19
    v_bfe_u32 v19, v1, 1, 1
    v_lshlrev_b32 v19, 4, v19
    v_add_u32 v18, v18, v19
    s_lshl_b32 s66, s6, 8
    v_add_u32 v18, s66, v18
    s_lshl_b32 s66, s6, 8
    s_add_u32 s66, s66, 4352
    v_mov_b32 v19, s66
    v_bfe_u32 v20, v1, 2, 2
    v_cmp_eq_u32 vcc, 0, v20
    s_nop 1
    v_cndmask_b32 v8, v19, v18, vcc
    v_cmp_eq_u32 vcc, 1, v20
    s_nop 1
    v_cndmask_b32 v9, v19, v18, vcc
    v_cmp_eq_u32 vcc, 2, v20
    s_nop 1
    v_cndmask_b32 v10, v19, v18, vcc
    v_cmp_eq_u32 vcc, 3, v20
    s_nop 1
    v_cndmask_b32 v11, v19, v18, vcc
    buffer_load_ushort v232, v6, s[56:59], 0 offen offset:0
    buffer_load_ushort v233, v6, s[56:59], 0 offen offset:16
    buffer_load_ushort v234, v6, s[56:59], 0 offen offset:32
    buffer_load_ushort v235, v6, s[56:59], 0 offen offset:48
    buffer_load_ushort v236, v15, s[60:63], s65 offen offset:0
    buffer_load_ushort v237, v15, s[60:63], s65 offen offset:16
    buffer_load_ushort v238, v15, s[60:63], s65 offen offset:32
    buffer_load_ushort v239, v15, s[60:63], s65 offen offset:48
    s_lshl_b32 s73, s11, 8
    s_add_u32 s68, s73, 720896
    s_bfe_u32 s66, s6, 0x10001
    s_mul_i32 s66, s66, 16384
    s_and_b32 s67, s6, 1
    s_lshl_b32 s67, s67, 7
    s_add_u32 s68, s68, s66
    s_add_u32 s68, s68, s67
    v_lshlrev_b32 v16, 2, v1
    v_mov_b32 v17, 0
    s_mov_b32 exec_lo, -1
    s_mov_b32 exec_hi, 0
    ds_write_b32 v16, v17 offset:15104
    s_mov_b64 exec, -1
    v_lshrrev_b32 v51, 5, v1
    v_lshlrev_b32 v51, 5, v51
    s_waitcnt lgkmcnt(0)
    s_barrier
    s_waitcnt vmcnt(16)
    v_perm_b32 v128, v68, v64, s46
    v_perm_b32 v129, v76, v72, s46
    v_perm_b32 v130, v84, v80, s46
    v_perm_b32 v131, v92, v88, s46
    v_perm_b32 v132, v68, v64, s47
    v_perm_b32 v133, v76, v72, s47
    v_perm_b32 v134, v84, v80, s47
    v_perm_b32 v135, v92, v88, s47
    v_perm_b32 v136, v69, v65, s46
    v_perm_b32 v137, v77, v73, s46
    v_perm_b32 v138, v85, v81, s46
    v_perm_b32 v139, v93, v89, s46
    v_perm_b32 v140, v69, v65, s47
    v_perm_b32 v141, v77, v73, s47
    v_perm_b32 v142, v85, v81, s47
    v_perm_b32 v143, v93, v89, s47
    v_perm_b32 v144, v70, v66, s46
    v_perm_b32 v145, v78, v74, s46
    v_perm_b32 v146, v86, v82, s46
    v_perm_b32 v147, v94, v90, s46
    v_perm_b32 v148, v70, v66, s47
    v_perm_b32 v149, v78, v74, s47
    v_perm_b32 v150, v86, v82, s47
    v_perm_b32 v151, v94, v90, s47
    v_perm_b32 v152, v71, v67, s46
    v_perm_b32 v153, v79, v75, s46
    v_perm_b32 v154, v87, v83, s46
    v_perm_b32 v155, v95, v91, s46
    v_perm_b32 v156, v71, v67, s47
    v_perm_b32 v157, v79, v75, s47
    v_perm_b32 v158, v87, v83, s47
    v_perm_b32 v159, v95, v91, s47
    s_waitcnt vmcnt(8)
    v_perm_b32 v160, v100, v96, s46
    v_perm_b32 v161, v108, v104, s46
    v_perm_b32 v162, v116, v112, s46
    v_perm_b32 v163, v124, v120, s46
    v_perm_b32 v164, v100, v96, s47
    v_perm_b32 v165, v108, v104, s47
    v_perm_b32 v166, v116, v112, s47
    v_perm_b32 v167, v124, v120, s47
    v_perm_b32 v168, v101, v97, s46
    v_perm_b32 v169, v109, v105, s46
    v_perm_b32 v170, v117, v113, s46
    v_perm_b32 v171, v125, v121, s46
    v_perm_b32 v172, v101, v97, s47
    v_perm_b32 v173, v109, v105, s47
    v_perm_b32 v174, v117, v113, s47
    v_perm_b32 v175, v125, v121, s47
    v_perm_b32 v176, v102, v98, s46
    v_perm_b32 v177, v110, v106, s46
    v_perm_b32 v178, v118, v114, s46
    v_perm_b32 v179, v126, v122, s46
    v_perm_b32 v180, v102, v98, s47
    v_perm_b32 v181, v110, v106, s47
    v_perm_b32 v182, v118, v114, s47
    v_perm_b32 v183, v126, v122, s47
    v_perm_b32 v184, v103, v99, s46
    v_perm_b32 v185, v111, v107, s46
    v_perm_b32 v186, v119, v115, s46
    v_perm_b32 v187, v127, v123, s46
    v_perm_b32 v188, v103, v99, s47
    v_perm_b32 v189, v111, v107, s47
    v_perm_b32 v190, v119, v115, s47
    v_perm_b32 v191, v127, v123, s47
    s_waitcnt vmcnt(0)
    v_lshlrev_b32 v232, 16, v232
    v_lshlrev_b32 v236, 16, v236
    v_lshlrev_b32 v233, 16, v233
    v_lshlrev_b32 v237, 16, v237
    v_lshlrev_b32 v234, 16, v234
    v_lshlrev_b32 v238, 16, v238
    v_lshlrev_b32 v235, 16, v235
    v_lshlrev_b32 v239, 16, v239
    s_mov_b32 s16, 20480
    s_mov_b32 s17, 69632
    s_mov_b32 s18, 36864
    s_mov_b32 s19, 86016
    s_mov_b32 s20, 28672
    s_mov_b32 s21, 77824
    s_mov_b32 s70, 200000
L_poll_20:
    s_cmp_lg_u32 s96, 0
    s_cbranch_scc1 L_psk_22
    buffer_load_dwordx4 v[20:23], v4, s[48:51], s16 offen sc1
    buffer_load_dwordx4 v[24:27], v4, s[48:51], s17 offen sc1
    buffer_load_dwordx4 v[28:31], v4, s[48:51], s18 offen sc1
    buffer_load_dwordx4 v[32:35], v4, s[48:51], s19 offen sc1
    buffer_load_dwordx4 v[36:39], v4, s[48:51], s20 offen sc1
    buffer_load_dwordx4 v[40:43], v4, s[48:51], s21 offen sc1
    s_waitcnt vmcnt(0)
L_psk_22:
    v_xor_b32 v20, v13, v20
    v_xor_b32 v21, v13, v21
    v_or_b32 v16, v20, v21
    v_xor_b32 v22, v13, v22
    v_xor_b32 v23, v13, v23
    v_or3_b32 v16, v16, v22, v23
    v_xor_b32 v24, v13, v24
    v_xor_b32 v25, v13, v25
    v_or3_b32 v16, v16, v24, v25
    v_xor_b32 v26, v13, v26
    v_xor_b32 v27, v13, v27
    v_or3_b32 v16, v16, v26, v27
    v_xor_b32 v28, v13, v28
    v_xor_b32 v29, v13, v29
    v_or3_b32 v16, v16, v28, v29
    v_xor_b32 v30, v13, v30
    v_xor_b32 v31, v13, v31
    v_or3_b32 v16, v16, v30, v31
    v_xor_b32 v32, v13, v32
    v_xor_b32 v33, v13, v33
    v_or3_b32 v16, v16, v32, v33
    v_xor_b32 v34, v13, v34
    v_xor_b32 v35, v13, v35
    v_or3_b32 v16, v16, v34, v35
    v_xor_b32 v36, v13, v36
    v_xor_b32 v37, v13, v37
    v_or3_b32 v16, v16, v36, v37
    v_xor_b32 v38, v13, v38
    v_xor_b32 v39, v13, v39
    v_or3_b32 v16, v16, v38, v39
    v_xor_b32 v40, v13, v40
    v_xor_b32 v41, v13, v41
    v_or3_b32 v16, v16, v40, v41
    v_xor_b32 v42, v13, v42
    v_xor_b32 v43, v13, v43
    v_or3_b32 v16, v16, v42, v43
    v_and_b32 v16, 0xff, v16
    v_cmp_ne_u32 vcc, 0, v16
    s_nop 1
    s_cbranch_vccz L_pdone_21
    s_cmp_lg_u32 s96, 0
    s_cbranch_scc1 L_pdone_21
    s_sub_u32 s70, s70, 1
    s_cmp_lg_u32 s70, 0
    s_cbranch_scc1 L_poll_20
L_pdone_21:
    v_pk_add_f32 v[240:241], v[20:21], v[24:25]
    v_pk_add_f32 v[242:243], v[22:23], v[26:27]
    v_pk_add_f32 v[244:245], v[28:29], v[32:33]
    v_pk_add_f32 v[246:247], v[30:31], v[34:35]
    v_pk_add_f32 v[248:249], v[36:37], v[40:41]
    v_pk_add_f32 v[250:251], v[38:39], v[42:43]
    v_cvt_pk_bf16_f32 v28, v240, v241
    v_cvt_pk_bf16_f32 v29, v242, v243
    v_lshlrev_b32 v240, 16, v28
    v_and_b32 v241, 0xffff0000, v28
    v_lshlrev_b32 v242, 16, v29
    v_and_b32 v243, 0xffff0000, v29
    v_cvt_pk_bf16_f32 v28, v248, v249
    v_cvt_pk_bf16_f32 v29, v250, v251
    v_lshlrev_b32 v248, 16, v28
    v_and_b32 v249, 0xffff0000, v28
    v_lshlrev_b32 v250, 16, v29
    v_and_b32 v251, 0xffff0000, v29
    v_cvt_pk_bf16_f32 v28, v244, v245
    v_cvt_pk_bf16_f32 v29, v246, v247
    v_lshlrev_b32 v244, 16, v28
    v_and_b32 v245, 0xffff0000, v28
    v_lshlrev_b32 v246, 16, v29
    v_and_b32 v247, 0xffff0000, v29
    v_pk_add_f32 v[244:245], v[244:245], 1.0 op_sel_hi:[1,0]
    v_pk_add_f32 v[246:247], v[246:247], 1.0 op_sel_hi:[1,0]
    v_cvt_pk_bf16_f32 v28, v244, v245
    v_cvt_pk_bf16_f32 v29, v246, v247
    v_lshlrev_b32 v244, 16, v28
    v_and_b32 v245, 0xffff0000, v28
    v_lshlrev_b32 v246, 16, v29
    v_and_b32 v247, 0xffff0000, v29
    v_add_f32 v16, v244, v245
    v_mul_f32 v17, v244, v244
    v_add_f32 v18, v248, v249
    v_mul_f32 v19, v248, v248
    v_mul_f32 v20, v244, v248
    v_add_f32 v16, v16, v246
    v_add_f32 v18, v18, v250
    v_add_f32 v16, v16, v247
    v_add_f32 v18, v18, v251
    v_fmac_f32 v17, v245, v245
    v_fmac_f32 v19, v249, v249
    v_fmac_f32 v20, v245, v249
    v_fmac_f32 v17, v246, v246
    v_fmac_f32 v19, v250, v250
    v_fmac_f32 v20, v246, v250
    v_fmac_f32 v17, v247, v247
    v_fmac_f32 v19, v251, v251
    v_fmac_f32 v20, v247, v251
    v_add_f32_dpp v16, v16, v16 row_ror:1 row_mask:0xf bank_mask:0xf
    v_add_f32_dpp v17, v17, v17 row_ror:1 row_mask:0xf bank_mask:0xf
    v_add_f32_dpp v18, v18, v18 row_ror:1 row_mask:0xf bank_mask:0xf
    v_add_f32_dpp v19, v19, v19 row_ror:1 row_mask:0xf bank_mask:0xf
    v_add_f32_dpp v20, v20, v20 row_ror:1 row_mask:0xf bank_mask:0xf
    v_add_f32_dpp v16, v16, v16 row_ror:2 row_mask:0xf bank_mask:0xf
    v_add_f32_dpp v17, v17, v17 row_ror:2 row_mask:0xf bank_mask:0xf
    v_add_f32_dpp v18, v18, v18 row_ror:2 row_mask:0xf bank_mask:0xf
    v_add_f32_dpp v19, v19, v19 row_ror:2 row_mask:0xf bank_mask:0xf
    v_add_f32_dpp v20, v20, v20 row_ror:2 row_mask:0xf bank_mask:0xf
    v_add_f32_dpp v16, v16, v16 row_ror:4 row_mask:0xf bank_mask:0xf
    v_add_f32_dpp v17, v17, v17 row_ror:4 row_mask:0xf bank_mask:0xf
    v_add_f32_dpp v18, v18, v18 row_ror:4 row_mask:0xf bank_mask:0xf
    v_add_f32_dpp v19, v19, v19 row_ror:4 row_mask:0xf bank_mask:0xf
    v_add_f32_dpp v20, v20, v20 row_ror:4 row_mask:0xf bank_mask:0xf
    v_add_f32_dpp v16, v16, v16 row_ror:8 row_mask:0xf bank_mask:0xf
    v_add_f32_dpp v17, v17, v17 row_ror:8 row_mask:0xf bank_mask:0xf
    v_add_f32_dpp v18, v18, v18 row_ror:8 row_mask:0xf bank_mask:0xf
    v_add_f32_dpp v19, v19, v19 row_ror:8 row_mask:0xf bank_mask:0xf
    v_add_f32_dpp v20, v20, v20 row_ror:8 row_mask:0xf bank_mask:0xf
    s_mov_b32 exec_lo, 0x00010001
    s_mov_b32 exec_hi, 0x00010001
    ds_add_f32 v51, v16 offset:15168
    ds_add_f32 v51, v17 offset:15172
    ds_add_f32 v51, v18 offset:15176
    ds_add_f32 v51, v19 offset:15180
    ds_add_f32 v51, v20 offset:15184
    s_mov_b64 exec, -1
    s_waitcnt lgkmcnt(0)
    s_barrier
    ds_read_b128 v[52:55], v51 offset:15168
    ds_read_b32 v56, v51 offset:15184
    s_waitcnt lgkmcnt(0)
    s_mov_b32 s96, 1
    s_cmp_eq_u32 s6, 0
    s_cbranch_scc1 L_u_sec0
    s_cmp_eq_u32 s6, 1
    s_cbranch_scc1 L_u_sec1
    s_cmp_eq_u32 s6, 2
    s_cbranch_scc1 L_u_sec2
    s_cmp_eq_u32 s6, 3
    s_cbranch_scc1 L_u_sec3
    s_branch L_u_drydone
L_u_real:
L_u_sec0:
    s_mov_b32 s66, 688128
    s_mov_b32 s67, 696320
    s_mov_b32 s73, 704512
    s_mov_b32 s74, 712704
    s_mov_b32 s70, 200000
L_poll_23:
    s_cmp_lg_u32 s96, 0
    s_cbranch_scc1 L_psk_25
    buffer_load_dwordx4 v[20:23], v4, s[48:51], s66 offen sc1
    buffer_load_dwordx4 v[24:27], v4, s[48:51], s67 offen sc1
    buffer_load_dwordx4 v[28:31], v4, s[48:51], s73 offen sc1
    buffer_load_dwordx4 v[32:35], v4, s[48:51], s74 offen sc1
    s_waitcnt vmcnt(0)
L_psk_25:
    v_xor_b32 v20, v13, v20
    v_xor_b32 v21, v13, v21
    v_or_b32 v16, v20, v21
    v_xor_b32 v22, v13, v22
    v_xor_b32 v23, v13, v23
    v_or3_b32 v16, v16, v22, v23
    v_xor_b32 v24, v13, v24
    v_xor_b32 v25, v13, v25
    v_or3_b32 v16, v16, v24, v25
    v_xor_b32 v26, v13, v26
    v_xor_b32 v27, v13, v27
    v_or3_b32 v16, v16, v26, v27
    v_xor_b32 v28, v13, v28
    v_xor_b32 v29, v13, v29
    v_or3_b32 v16, v16, v28, v29
    v_xor_b32 v30, v13, v30
    v_xor_b32 v31, v13, v31
    v_or3_b32 v16, v16, v30, v31
    v_xor_b32 v32, v13, v32
    v_xor_b32 v33, v13, v33
    v_or3_b32 v16, v16, v32, v33
    v_xor_b32 v34, v13, v34
    v_xor_b32 v35, v13, v35
    v_or3_b32 v16, v16, v34, v35
    v_and_b32 v16, 0xff, v16
    v_cmp_ne_u32 vcc, 0, v16
    s_nop 1
    s_cbranch_vccz L_pdone_24
    s_cmp_lg_u32 s96, 0
    s_cbranch_scc1 L_pdone_24
    s_sub_u32 s70, s70, 1
    s_cmp_lg_u32 s70, 0
    s_cbranch_scc1 L_poll_23
L_pdone_24:
    v_pk_add_f32 v[20:21], v[20:21], v[24:25]
    v_pk_add_f32 v[22:23], v[22:23], v[26:27]
    v_pk_add_f32 v[28:29], v[28:29], v[32:33]
    v_pk_add_f32 v[30:31], v[30:31], v[34:35]
    v_pk_add_f32 v[20:21], v[20:21], v[28:29]
    v_pk_add_f32 v[22:23], v[22:23], v[30:31]
    v_pk_fma_f32 v[20:21], v[240:241], v[20:21], v[232:233]
    v_pk_fma_f32 v[22:23], v[242:243], v[22:23], v[234:235]
    v_pk_mul_f32 v[252:253], v[20:21], v[244:245]
    v_pk_mul_f32 v[254:255], v[22:23], v[246:247]
    v_pk_add_f32 v[24:25], v[20:21], v[22:23]
    v_pk_mul_f32 v[26:27], v[20:21], v[20:21]
    v_pk_add_f32 v[28:29], v[252:253], v[254:255]
    v_pk_mul_f32 v[30:31], v[252:253], v[252:253]
    v_pk_mul_f32 v[32:33], v[252:253], v[244:245]
    v_pk_mul_f32 v[34:35], v[252:253], v[248:249]
    v_pk_fma_f32 v[26:27], v[22:23], v[22:23], v[26:27]
    v_pk_fma_f32 v[30:31], v[254:255], v[254:255], v[30:31]
    v_pk_fma_f32 v[32:33], v[254:255], v[246:247], v[32:33]
    v_pk_fma_f32 v[34:35], v[254:255], v[250:251], v[34:35]
    v_add_f32 v36, v24, v25
    v_add_f32 v37, v26, v27
    v_add_f32 v38, v28, v29
    v_add_f32 v39, v30, v31
    v_add_f32 v40, v32, v33
    v_add_f32 v41, v34, v35
    v_add_f32_dpp v36, v36, v36 row_ror:1 row_mask:0xf bank_mask:0xf
    v_add_f32_dpp v37, v37, v37 row_ror:1 row_mask:0xf bank_mask:0xf
    v_add_f32_dpp v38, v38, v38 row_ror:1 row_mask:0xf bank_mask:0xf
    v_add_f32_dpp v39, v39, v39 row_ror:1 row_mask:0xf bank_mask:0xf
    v_add_f32_dpp v40, v40, v40 row_ror:1 row_mask:0xf bank_mask:0xf
    v_add_f32_dpp v41, v41, v41 row_ror:1 row_mask:0xf bank_mask:0xf
    v_add_f32_dpp v36, v36, v36 row_ror:2 row_mask:0xf bank_mask:0xf
    v_add_f32_dpp v37, v37, v37 row_ror:2 row_mask:0xf bank_mask:0xf
    v_add_f32_dpp v38, v38, v38 row_ror:2 row_mask:0xf bank_mask:0xf
    v_add_f32_dpp v39, v39, v39 row_ror:2 row_mask:0xf bank_mask:0xf
    v_add_f32_dpp v40, v40, v40 row_ror:2 row_mask:0xf bank_mask:0xf
    v_add_f32_dpp v41, v41, v41 row_ror:2 row_mask:0xf bank_mask:0xf
    v_add_f32_dpp v36, v36, v36 row_ror:4 row_mask:0xf bank_mask:0xf
    v_add_f32_dpp v37, v37, v37 row_ror:4 row_mask:0xf bank_mask:0xf
    v_add_f32_dpp v38, v38, v38 row_ror:4 row_mask:0xf bank_mask:0xf
    v_add_f32_dpp v39, v39, v39 row_ror:4 row_mask:0xf bank_mask:0xf
    v_add_f32_dpp v40, v40, v40 row_ror:4 row_mask:0xf bank_mask:0xf
    v_add_f32_dpp v41, v41, v41 row_ror:4 row_mask:0xf bank_mask:0xf
    v_add_f32_dpp v36, v36, v36 row_ror:8 row_mask:0xf bank_mask:0xf
    v_add_f32_dpp v37, v37, v37 row_ror:8 row_mask:0xf bank_mask:0xf
    v_add_f32_dpp v38, v38, v38 row_ror:8 row_mask:0xf bank_mask:0xf
    v_add_f32_dpp v39, v39, v39 row_ror:8 row_mask:0xf bank_mask:0xf
    v_add_f32_dpp v40, v40, v40 row_ror:8 row_mask:0xf bank_mask:0xf
    v_add_f32_dpp v41, v41, v41 row_ror:8 row_mask:0xf bank_mask:0xf
    s_mov_b32 exec_lo, 0x00010001
    s_mov_b32 exec_hi, 0x00010001
    s_cmp_lg_u32 s96, 0
    s_cbranch_scc1 L_nd_26
    ds_add_f32 v51, v36 offset:15104
    ds_add_f32 v51, v37 offset:15108
    ds_add_f32 v51, v38 offset:15112
    ds_add_f32 v51, v39 offset:15116
    ds_add_f32 v51, v40 offset:15120
    ds_add_f32 v51, v41 offset:15124
L_nd_26:
    s_mov_b64 exec, -1
    s_waitcnt lgkmcnt(0)
    s_cmp_lg_u32 s96, 0
    s_cbranch_scc1 L_u_drydone
    s_barrier
L_u_sec1:
    ds_read_b128 v[36:39], v51 offset:15104
    ds_read_b64 v[40:41], v51 offset:15120
    s_mov_b32 s75, 0x3a800000
    s_waitcnt lgkmcnt(0)
    v_mul_f32 v16, s75, v36
    v_mul_f32 v17, s75, v37
    v_fma_f32 v17, -v16, v16, v17
    v_fma_f32 v18, -v16, v52, v38
    v_fma_f32 v19, -v16, v40, v39
    v_add_f32 v17, 0x3727c5ac, v17
    v_fma_f32 v19, -v16, v40, v19
    v_rsq_f32 v17, v17
    v_mul_f32 v20, v16, v16
    v_fma_f32 v21, -v16, v56, v41
    v_fma_f32 v19, v20, v53, v19
    v_fma_f32 v18, v17, v18, v54
    v_mul_f32 v20, v17, v17
    v_add_f32 v22, v17, v17
    v_mul_f32 v18, s75, v18
    v_fma_f32 v19, v20, v19, v55
    v_fma_f32 v19, v22, v21, v19
    v_mul_f32 v19, s75, v19
    v_fma_f32 v19, -v18, v18, v19
    v_add_f32 v19, 0x3727c5ac, v19
    v_rsq_f32 v19, v19
    s_nop 0
    v_mul_f32 v24, v17, v19
    v_mul_f32 v26, -v18, v19
    v_mul_f32 v25, -v16, v24
    v_pk_fma_f32 v[20:21], v[248:249], v[18:19], v[26:27] op_sel:[0,1,0] op_sel_hi:[1,1,0]
    v_pk_fma_f32 v[22:23], v[250:251], v[18:19], v[26:27] op_sel:[0,1,0] op_sel_hi:[1,1,0]
    v_pk_fma_f32 v[20:21], v[244:245], v[24:25], v[20:21] op_sel:[0,1,0] op_sel_hi:[1,1,1]
    v_pk_fma_f32 v[22:23], v[246:247], v[24:25], v[22:23] op_sel:[0,1,0] op_sel_hi:[1,1,1]
    v_pk_fma_f32 v[20:21], v[252:253], v[24:25], v[20:21] op_sel:[0,0,0] op_sel_hi:[1,0,1]
    v_pk_fma_f32 v[22:23], v[254:255], v[24:25], v[22:23] op_sel:[0,0,0] op_sel_hi:[1,0,1]
    v_cvt_pk_bf16_f32 v28, v20, v21
    v_cvt_pk_bf16_f32 v29, v22, v23
    ds_write_b64 v7, v[28:29]
    s_cmp_lg_u32 s96, 0
    s_cbranch_scc1 L_u_drydone
L_u_sec2:
    s_waitcnt lgkmcnt(0)
    ds_read_b128 v[200:203], v8 offset:0
    ds_read_b128 v[204:207], v9 offset:0
    ds_read_b128 v[208:211], v10 offset:0
    ds_read_b128 v[212:215], v11 offset:0
    ds_read_b128 v[216:219], v8 offset:128
    ds_read_b128 v[220:223], v9 offset:128
    ds_read_b128 v[224:227], v10 offset:128
    ds_read_b128 v[228:231], v11 offset:128
    s_waitcnt lgkmcnt(7)
    v_mfma_f32_16x16x32_bf16 v[192:195], v[128:131], v[200:203], 0
    v_mfma_f32_16x16x32_bf16 v[196:199], v[144:147], v[200:203], 0
    s_waitcnt lgkmcnt(6)
    v_mfma_f32_16x16x32_bf16 v[192:195], v[132:135], v[204:207], v[192:195]
    v_mfma_f32_16x16x32_bf16 v[196:199], v[148:151], v[204:207], v[196:199]
    s_waitcnt lgkmcnt(5)
    v_mfma_f32_16x16x32_bf16 v[192:195], v[136:139], v[208:211], v[192:195]
    v_mfma_f32_16x16x32_bf16 v[196:199], v[152:155], v[208:211], v[196:199]
    s_waitcnt lgkmcnt(4)
    v_mfma_f32_16x16x32_bf16 v[192:195], v[140:143], v[212:215], v[192:195]
    v_mfma_f32_16x16x32_bf16 v[196:199], v[156:159], v[212:215], v[196:199]
    s_waitcnt lgkmcnt(3)
    v_mfma_f32_16x16x32_bf16 v[192:195], v[160:163], v[216:219], v[192:195]
    v_mfma_f32_16x16x32_bf16 v[196:199], v[176:179], v[216:219], v[196:199]
    s_waitcnt lgkmcnt(2)
    v_mfma_f32_16x16x32_bf16 v[192:195], v[164:167], v[220:223], v[192:195]
    v_mfma_f32_16x16x32_bf16 v[196:199], v[180:183], v[220:223], v[196:199]
    s_waitcnt lgkmcnt(1)
    v_mfma_f32_16x16x32_bf16 v[192:195], v[168:171], v[224:227], v[192:195]
    v_mfma_f32_16x16x32_bf16 v[196:199], v[184:187], v[224:227], v[196:199]
    s_waitcnt lgkmcnt(0)
    v_mfma_f32_16x16x32_bf16 v[192:195], v[172:175], v[228:231], v[192:195]
    v_mfma_f32_16x16x32_bf16 v[196:199], v[188:191], v[228:231], v[196:199]
    s_mov_b32 exec_lo, 0x33333333
    s_mov_b32 exec_hi, 0xcccccccc
    s_nop 4
    ds_write_b128 v48, v[192:195]
    ds_write_b128 v48, v[196:199] offset:1088
    s_mov_b64 exec, -1
    s_waitcnt lgkmcnt(0)
    s_cmp_lg_u32 s96, 0
    s_cbranch_scc1 L_u_drydone
    s_barrier
    s_cmp_ge_u32 s6, 4
    s_cbranch_scc1 L_epi_done_u
L_u_sec3:
    ds_read_b128 v[20:23], v49
    ds_read_b128 v[24:27], v49 offset:16
    s_waitcnt lgkmcnt(0)
    v_pk_add_f32 v[20:21], v[20:21], v[24:25]
    v_pk_add_f32 v[22:23], v[22:23], v[26:27]
    s_nop 0
    v_add_f32_dpp v20, v20, v20 quad_perm:[1,0,3,2] row_mask:0xf bank_mask:0xf
    v_add_f32_dpp v21, v21, v21 quad_perm:[1,0,3,2] row_mask:0xf bank_mask:0xf
    v_add_f32_dpp v22, v22, v22 quad_perm:[1,0,3,2] row_mask:0xf bank_mask:0xf
    v_add_f32_dpp v23, v23, v23 quad_perm:[1,0,3,2] row_mask:0xf bank_mask:0xf
    v_add_f32_dpp v20, v20, v20 quad_perm:[2,3,0,1] row_mask:0xf bank_mask:0xf
    v_add_f32_dpp v21, v21, v21 quad_perm:[2,3,0,1] row_mask:0xf bank_mask:0xf
    v_add_f32_dpp v22, v22, v22 quad_perm:[2,3,0,1] row_mask:0xf bank_mask:0xf
    v_add_f32_dpp v23, v23, v23 quad_perm:[2,3,0,1] row_mask:0xf bank_mask:0xf
    v_add_f32_dpp v20, v20, v20 row_half_mirror row_mask:0xf bank_mask:0xf
    v_add_f32_dpp v21, v21, v21 row_half_mirror row_mask:0xf bank_mask:0xf
    v_add_f32_dpp v22, v22, v22 row_half_mirror row_mask:0xf bank_mask:0xf
    v_add_f32_dpp v23, v23, v23 row_half_mirror row_mask:0xf bank_mask:0xf
    v_cvt_pk_bf16_f32 v28, v20, v21
    v_cvt_pk_bf16_f32 v29, v22, v23
    v_lshlrev_b32 v20, 16, v28
    v_and_b32 v21, 0xffff0000, v28
    v_lshlrev_b32 v22, 16, v29
    v_and_b32 v23, 0xffff0000, v29
    v_pk_add_f32 v[20:21], v[20:21], v[236:237]
    v_pk_add_f32 v[22:23], v[22:23], v[238:239]
    v_cvt_pk_bf16_f32 v28, v20, v21
    v_cvt_pk_bf16_f32 v29, v22, v23
    v_lshlrev_b32 v20, 16, v28
    v_and_b32 v21, 0xffff0000, v28
    v_lshlrev_b32 v22, 16, v29
    v_and_b32 v23, 0xffff0000, v29
    s_mov_b32 s75, 0xbdd2d3e8
    v_mov_b32 v32, 0xc0135761
    v_mul_f32 v24, v20, v20
    v_mul_f32 v25, v21, v21
    v_mul_f32 v26, v22, v22
    v_mul_f32 v27, v23, v23
    v_fma_f32 v24, v24, s75, v32
    v_fma_f32 v25, v25, s75, v32
    v_fma_f32 v26, v26, s75, v32
    v_fma_f32 v27, v27, s75, v32
    v_mul_f32 v24, v24, v20
    v_mul_f32 v25, v25, v21
    v_mul_f32 v26, v26, v22
    v_mul_f32 v27, v27, v23
    v_exp_f32 v24, v24
    v_exp_f32 v25, v25
    v_exp_f32 v26, v26
    v_exp_f32 v27, v27
    v_add_f32 v24, 1.0, v24
    v_add_f32 v25, 1.0, v25
    v_add_f32 v26, 1.0, v26
    v_add_f32 v27, 1.0, v27
    v_rcp_f32 v24, v24
    v_rcp_f32 v25, v25
    v_rcp_f32 v26, v26
    v_rcp_f32 v27, v27
    v_mul_f32 v20, v20, v24
    v_mul_f32 v21, v21, v25
    v_mul_f32 v22, v22, v26
    v_mul_f32 v23, v23, v27
    v_cvt_pk_bf16_f32 v25, v20, v21
    v_cvt_pk_bf16_f32 v27, v22, v23
    v_lshl_or_b32 v24, v25, 16, v12
    v_lshl_or_b32 v26, v27, 16, v12
    v_and_or_b32 v25, v25, s71, v12
    v_and_or_b32 v27, v27, s71, v12
    s_mov_b32 exec_lo, 0x01010101
    s_mov_b32 exec_hi, 0x01010101
    s_cmp_lg_u32 s96, 0
    s_cbranch_scc1 L_nd_27
    buffer_store_dwordx4 v[24:27], v50, s[48:51], s68 offen sc1
L_nd_27:
    s_mov_b64 exec, -1
L_epi_done_u:
    s_cmp_eq_u32 s96, 0
    s_cbranch_scc1 L_u_out
L_u_drydone:
    s_mov_b32 s96, 0
    s_barrier
    s_branch L_u_real
L_u_out:
    s_branch L_Fdone
L_Fdone:
    s_branch L_fin
L_Estart:
    s_sub_u32 s66, s8, 16
    s_cmp_ge_u32 s8, 24
    s_cselect_b32 s8, s66, s8
    s_waitcnt lgkmcnt(0)
    s_mov_b32 s48, s44
    s_mov_b32 s49, s45
    s_mov_b32 s50, 4194304
    s_mov_b32 s51, 0x00020000
    buffer_load_dword v244, off, s[48:51], 0 sc1
L_E:
    s_and_b32 s76, s7, 1
    s_lshr_b32 s77, s7, 1
    s_lshl_b32 s66, s76, 2
    s_add_u32 s66, s66, s77
    s_lshl_b32 s66, s66, 23
    s_lshl_b32 s67, s8, 16
    s_add_u32 s66, s66, s67
    s_add_u32 s78, s66, 7340032
    v_and_b32 v16, 15, v1
    v_lshrrev_b32 v17, 4, v1
    s_lshl_b32 s66, s6, 5
    v_add_u32 v18, s66, v17
    v_lshlrev_b32 v18, 8, v18
    v_lshlrev_b32 v19, 4, v16
    v_add_u32 v2, v18, v19
    v_lshlrev_b32 v18, 2, v17
    v_add_u32 v18, s66, v18
    v_lshlrev_b32 v18, 8, v18
    v_lshlrev_b32 v19, 4, v16
    v_add_u32 v3, v18, v19
    s_waitcnt lgkmcnt(0)
    s_add_u32 s30, s78, 4096
    s_mov_b32 s52, s18
    s_mov_b32 s53, s19
    s_mov_b32 s54, 67108864
    s_mov_b32 s55, 0x00020000
    s_mov_b32 s56, s20
    s_mov_b32 s57, s21
    s_mov_b32 s58, 67108864
    s_mov_b32 s59, 0x00020000
    v_lshrrev_b32 v17, 4, v1
    s_mov_b32 s26, 0xffffff00
    s_mov_b32 s34, 0xff00ff00
    s_mov_b32 s35, 0xff00ff00
    v_and_b32 v18, 31, v1
    v_lshlrev_b32 v4, 4, v18
    s_lshl_b32 s66, s76, 14
    s_lshl_b32 s67, s77, 12
    s_add_u32 s73, s66, s67
    s_lshl_b32 s67, s6, 9
    s_add_u32 s66, s73, s67
    s_add_u32 s97, s66, 1114112
    v_lshrrev_b32 v19, 3, v18
    v_lshlrev_b32 v19, 6, v19
    v_and_b32 v20, 7, v1
    v_lshlrev_b32 v20, 1, v20
    v_add_u32 v19, v19, v20
    s_mul_i32 s66, s6, 288
    v_add_u32 v5, s66, v19
    v_and_b32 v19, 7, v1
    v_mul_u32_u24 v19, 288, v19
    v_lshlrev_b32 v20, 4, v17
    v_add_u32 v6, v19, v20
    v_and_b32 v19, 7, v1
    v_lshlrev_b32 v7, 5, v19
    s_and_b32 s66, s6, 1
    s_lshl_b32 s66, s66, 4
    s_lshr_b32 s67, s6, 1
    s_lshl_b32 s67, s67, 2
    s_add_u32 s66, s66, s67
    v_add_u32 v7, s66, v7
    v_and_b32 v20, 1, v1
    v_lshlrev_b32 v11, 4, v20
    s_lshl_b32 s66, s6, 5
    v_add_u32 v11, s66, v11
    v_lshlrev_b32 v20, 9, v19
    v_lshlrev_b32 v21, 7, v17
    v_add_u32 v20, v20, v21
    v_bfe_u32 v21, v1, 3, 1
    v_xor_b32 v21, v21, v19
    v_lshlrev_b32 v21, 4, v21
    v_add_u32 v20, v20, v21
    s_mul_i32 s66, s6, 4224
    s_add_u32 s66, s66, 4096
    v_add_u32 v240, s66, v20
    v_xor_b32 v241, 32, v240
    v_xor_b32 v242, 64, v240
    v_xor_b32 v243, 96, v240
    v_and_b32 v19, 1, v1
    v_mul_u32_u24 v19, 4224, v19
    v_lshlrev_b32 v20, 7, v17
    v_add_u32 v19, v19, v20
    v_bfe_u32 v20, v1, 1, 3
    v_xor_b32 v20, s6, v20
    v_lshlrev_b32 v20, 4, v20
    v_add_u32 v19, v19, v20
    s_lshl_b32 s66, s6, 9
    s_add_u32 s66, s66, 4096
    v_add_u32 v9, s66, v19
    v_lshrrev_b32 v19, 1, v1
    v_lshlrev_b32 v19, 4, v19
    s_lshl_b32 s66, s6, 9
    v_add_u32 v10, s66, v19
    v_and_b32 v16, 3, v1
    v_bfe_u32 v17, v1, 2, 3
    v_lshrrev_b32 v18, 5, v1
    v_lshlrev_b32 v19, 12, v16
    v_lshlrev_b32 v20, 7, v18
    v_add_u32 v19, v19, v20
    v_lshlrev_b32 v21, 4, v17
    v_add_u32 v232, v19, v21
    v_lshlrev_b32 v233, 10, v16
    v_add_u32 v234, v20, v21
    s_lshr_b32 s74, s8, 1
    s_and_b32 s75, s8, 1
    s_lshl_b32 s74, s74, 9
    s_lshl_b32 s75, s75, 8
    s_add_u32 s74, s74, s75
    s_lshl_b32 s66, s7, 16
    s_add_u32 s66, s66, s74
    s_add_u32 s16, s66, 131072
    s_add_u32 s23, s16, 16384
    s_add_u32 s24, s16, 32768
    s_add_u32 s25, s16, 49152
    s_add_u32 s66, s73, s74
    s_add_u32 s22, s66, 655360
    s_lshl_b32 s66, s7, 14
    s_lshr_b32 s67, s8, 1
    s_lshl_b32 s67, s67, 7
    s_add_u32 s66, s66, s67
    s_add_u32 s17, s66, 917504
    s_lshl_b32 s66, s7, 16
    s_lshl_b32 s67, s8, 12
    s_add_u32 s66, s66, s67
    s_add_u32 s68, s66, 131072
    s_lshl_b32 s66, s7, 14
    s_lshl_b32 s67, s8, 10
    s_add_u32 s66, s66, s67
    s_lshl_b32 s67, s6, 7
    s_add_u32 s66, s66, s67
    s_add_u32 s72, s66, 917504
    v_lshrrev_b32 v17, 4, v1
    v_lshlrev_b32 v18, 12, v17
    v_and_b32 v16, 15, v1
    v_lshlrev_b32 v19, 4, v16
    v_add_u32 v235, v18, v19
    s_mul_i32 s66, s8, 224
    s_lshl_b32 s67, s6, 5
    s_add_u32 s66, s66, s67
    s_lshl_b32 s28, s66, 2
    s_add_u32 s28, s28, 720896
    v_and_b32 v18, 1, v1
    v_lshlrev_b32 v19, 14, v18
    v_lshlrev_b32 v20, 5, v17
    v_add_u32 v236, v19, v20
    s_lshl_b32 s66, s66, 11
    s_lshl_b32 s67, s7, 8
    s_add_u32 s29, s66, s67
    v_lshlrev_b32 v18, 9, v18
    v_lshlrev_b32 v19, 7, v17
    v_add_u32 v18, v18, v19
    s_lshl_b32 s66, s6, 10
    s_add_u32 s66, s66, 4096
    v_add_u32 v237, s66, v18
    v_lshlrev_b32 v238, 4, v1
    s_lshl_b32 s66, s7, 14
    s_lshl_b32 s67, s8, 10
    s_add_u32 s66, s66, s67
    s_add_u32 s69, s66, 753664
    v_mov_b32 v239, 0
    s_mov_b32 s60, s32
    s_mov_b32 s61, s33
    s_mov_b32 s62, 7340032
    s_mov_b32 s63, 0x00020000
    v_and_b32 v16, 1, v1
    v_mul_u32_u24 v18, 2176, v16
    v_lshrrev_b32 v19, 4, v1
    v_lshlrev_b32 v19, 5, v19
    v_add_u32 v18, v18, v19
    v_bfe_u32 v19, v1, 1, 1
    v_lshlrev_b32 v19, 4, v19
    v_add_u32 v18, v18, v19
    s_lshl_b32 s66, s6, 7
    v_add_u32 v18, s66, v18
    s_lshl_b32 s66, s6, 8
    s_add_u32 s66, s66, 4352
    v_mov_b32 v19, s66
    v_bfe_u32 v20, v1, 2, 2
    v_cmp_eq_u32 vcc, 0, v20
    s_nop 1
    v_cndmask_b32 v249, v19, v18, vcc
    v_cmp_eq_u32 vcc, 1, v20
    s_nop 1
    v_cndmask_b32 v250, v19, v18, vcc
    v_cmp_eq_u32 vcc, 2, v20
    s_nop 1
    v_cndmask_b32 v251, v19, v18, vcc
    v_cmp_eq_u32 vcc, 3, v20
    s_nop 1
    v_cndmask_b32 v252, v19, v18, vcc
    v_and_b32 v16, 1, v1
    v_lshlrev_b32 v16, 4, v16
    v_bfe_u32 v17, v1, 4, 1
    v_lshlrev_b32 v17, 3, v17
    v_add_u32 v16, v16, v17
    v_bfe_u32 v17, v1, 2, 2
    v_add_u32 v16, v16, v17
    v_mul_u32_u24 v16, 272, v16
    v_lshrrev_b32 v17, 5, v1
    v_lshlrev_b32 v17, 4, v17
    v_add_u32 v16, v16, v17
    s_lshl_b32 s66, s6, 5
    s_add_u32 s66, s66, 6400
    v_add_u32 v253, s66, v16
    v_lshrrev_b32 v16, 3, v1
    v_lshlrev_b32 v255, 4, v16
    v_mul_u32_u24 v16, 272, v16
    v_and_b32 v17, 7, v1
    v_lshlrev_b32 v17, 5, v17
    v_add_u32 v16, v16, v17
    s_and_b32 s66, s6, 3
    s_mul_i32 s66, s66, 2176
    s_add_u32 s66, s66, 6400
    v_add_u32 v254, s66, v16
    v_mov_b32 v248, 0
    s_mov_b32 s96, 1
    s_cmp_eq_u32 s6, 7
    s_cbranch_scc1 L_ea_sec0
    s_mov_b32 s96, 1
    s_cmp_eq_u32 s6, 0
    s_cbranch_scc1 L_e_sec0
    s_cmp_eq_u32 s6, 1
    s_cbranch_scc1 L_e_sec1
    s_cmp_eq_u32 s6, 2
    s_cbranch_scc1 L_e_sec2
    s_cmp_eq_u32 s6, 3
    s_cbranch_scc1 L_e_sec3
    s_cmp_eq_u32 s6, 4
    s_cbranch_scc1 L_e_sec4
    s_cmp_eq_u32 s6, 5
    s_cbranch_scc1 L_e_sec5
    s_cmp_eq_u32 s6, 6
    s_cbranch_scc1 L_e_sec6
    s_branch L_e_drydone
L_e_real:
    buffer_load_dwordx4 v[64:67], v2, s[52:55], s78 offen offset:0 nt
    buffer_load_dwordx4 v[68:71], v2, s[52:55], s78 offen offset:1024 nt
    buffer_load_dwordx4 v[72:75], v2, s[52:55], s78 offen offset:2048 nt
    buffer_load_dwordx4 v[76:79], v2, s[52:55], s78 offen offset:3072 nt
    buffer_load_dwordx4 v[80:83], v2, s[52:55], s30 offen offset:0 nt
    buffer_load_dwordx4 v[84:87], v2, s[52:55], s30 offen offset:1024 nt
    buffer_load_dwordx4 v[88:91], v2, s[52:55], s30 offen offset:2048 nt
    buffer_load_dwordx4 v[92:95], v2, s[52:55], s30 offen offset:3072 nt
    s_waitcnt vmcnt(16)
    buffer_load_dwordx4 v[96:99], v3, s[56:59], s78 offen offset:0 nt
    buffer_load_dwordx4 v[100:103], v3, s[56:59], s78 offen offset:256 nt
    buffer_load_dwordx4 v[104:107], v3, s[56:59], s78 offen offset:512 nt
    buffer_load_dwordx4 v[108:111], v3, s[56:59], s78 offen offset:768 nt
    s_waitcnt vmcnt(16)
    buffer_load_dwordx4 v[112:115], v3, s[56:59], s30 offen offset:0 nt
    buffer_load_dwordx4 v[116:119], v3, s[56:59], s30 offen offset:256 nt
    buffer_load_dwordx4 v[120:123], v3, s[56:59], s30 offen offset:512 nt
    buffer_load_dwordx4 v[124:127], v3, s[56:59], s30 offen offset:768 nt
    s_and_b32 s10, s8, 1
    s_lshr_b32 s73, s8, 1
    s_lshl_b32 s74, s7, 3
    s_add_u32 s73, s73, s74
    s_add_u32 s13, s73, 32
    s_mov_b32 s64, 12288
    s_lshl_b32 s65, s13, 7
    s_mov_b32 s52, s38
    s_mov_b32 s53, s39
    s_mov_b32 s54, 12582912
    s_mov_b32 s55, 0x00020000
    s_mov_b32 s56, s36
    s_mov_b32 s57, s37
    s_mov_b32 s58, 4096
    s_mov_b32 s59, 0x00020000
    v_lshrrev_b32 v16, 3, v1
    v_and_b32 v17, 3, v16
    v_lshlrev_b32 v17, 1, v17
    v_lshrrev_b32 v16, 2, v16
    v_lshlrev_b32 v16, 5, v16
    v_add_u32 v16, v16, v17
    s_lshl_b32 s66, s10, 9
    s_lshl_b32 s67, s6, 6
    s_add_u32 s66, s66, s67
    v_add_u32 v16, s66, v16
    v_mul_lo_u32 v246, v16, s64
    v_and_b32 v17, 7, v1
    v_lshlrev_b32 v17, 4, v17
    v_add_u32 v246, v246, v17
    v_bfe_u32 v16, v1, 4, 1
    v_and_b32 v17, 15, v1
    s_lshl_b32 s67, s6, 4
    v_add_u32 v17, s67, v17
    v_mul_u32_u24 v18, 2176, v16
    v_lshlrev_b32 v19, 3, v17
    v_add_u32 v248, v18, v19
    s_lshl_b32 s66, s10, 7
    v_add_u32 v17, s66, v17
    v_lshrrev_b32 v18, 3, v17
    v_lshlrev_b32 v18, 5, v18
    v_and_b32 v19, 7, v17
    v_add_u32 v18, v18, v19
    v_lshlrev_b32 v18, 1, v18
    v_lshlrev_b32 v19, 11, v16
    v_add_u32 v247, v18, v19
    buffer_load_ushort v228, v247, s[56:59], 0 offen offset:0
    buffer_load_ushort v229, v247, s[56:59], 0 offen offset:16
    buffer_load_ushort v230, v247, s[56:59], 0 offen offset:32
    buffer_load_ushort v231, v247, s[56:59], 0 offen offset:48
    s_waitcnt vmcnt(16)
    s_mul_i32 s66, s64, 0
    s_add_u32 s66, s66, s65
    buffer_load_dwordx4 v[160:163], v246, s[52:55], s66 offen nt
    s_mul_i32 s66, s64, 8
    s_add_u32 s66, s66, s65
    buffer_load_dwordx4 v[164:167], v246, s[52:55], s66 offen nt
    s_mul_i32 s66, s64, 16
    s_add_u32 s66, s66, s65
    buffer_load_dwordx4 v[168:171], v246, s[52:55], s66 offen nt
    s_mul_i32 s66, s64, 24
    s_add_u32 s66, s66, s65
    buffer_load_dwordx4 v[172:175], v246, s[52:55], s66 offen nt
    s_mul_i32 s66, s64, 1
    s_add_u32 s66, s66, s65
    buffer_load_dwordx4 v[176:179], v246, s[52:55], s66 offen nt
    s_mul_i32 s66, s64, 9
    s_add_u32 s66, s66, s65
    buffer_load_dwordx4 v[180:183], v246, s[52:55], s66 offen nt
    s_mul_i32 s66, s64, 17
    s_add_u32 s66, s66, s65
    buffer_load_dwordx4 v[184:187], v246, s[52:55], s66 offen nt
    s_mul_i32 s66, s64, 25
    s_add_u32 s66, s66, s65
    buffer_load_dwordx4 v[188:191], v246, s[52:55], s66 offen nt
    s_lshl_b32 s66, s6, 8
    s_add_u32 s66, s66, 4352
    v_lshlrev_b32 v20, 2, v1
    v_add_u32 v20, s66, v20
    v_mov_b32 v21, 0
    ds_write_b32 v20, v21
    s_mov_b32 s15, s68
    s_lshr_b32 s66, s13, 4
    s_and_b32 s67, s13, 15
    s_lshl_b32 s73, s66, 13
    s_lshl_b32 s74, s67, 8
    s_add_u32 s73, s73, s74
    s_mul_i32 s74, s10, 49152
    s_add_u32 s73, s73, s74
    s_add_u32 s68, s73, 4096
    s_bfe_u32 s66, s6, 0x10001
    s_mul_i32 s66, s66, 4096
    s_and_b32 s67, s6, 1
    s_lshl_b32 s67, s67, 7
    s_add_u32 s68, s68, s66
    s_add_u32 s68, s68, s67
    s_waitcnt vmcnt(12)
    v_add_u32 v245, 1, v244
    v_and_b32 v12, 0xffff, v245
    v_and_b32 v13, 0xff, v245
    s_lshl_b32 s66, s6, 13
    s_add_u32 s66, s66, 40960
    v_lshrrev_b32 v17, 4, v1
    v_and_b32 v16, 15, v1
    v_xor_b32 v18, v16, v17
    v_lshlrev_b32 v18, 4, v18
    v_lshlrev_b32 v19, 8, v17
    v_add_u32 v19, v19, v18
    v_add_u32 v19, s66, v19
    v_lshlrev_b32 v20, 8, v16
    v_add_u32 v20, v20, v18
    v_add_u32 v20, s66, v20
    v_xor_b32 v24, 0, v19
    v_xor_b32 v25, 64, v19
    v_xor_b32 v26, 128, v19
    v_xor_b32 v27, 192, v19
    v_xor_b32 v28, 0, v20
    v_xor_b32 v29, 64, v20
    v_xor_b32 v30, 128, v20
    v_xor_b32 v31, 192, v20
    ds_write_b128 v24, v[64:67] offset:0
    ds_write_b128 v25, v[68:71] offset:1024
    ds_write_b128 v26, v[72:75] offset:2048
    ds_write_b128 v27, v[76:79] offset:3072
    ds_write_b128 v24, v[80:83] offset:4096
    ds_write_b128 v25, v[84:87] offset:5120
    ds_write_b128 v26, v[88:91] offset:6144
    ds_write_b128 v27, v[92:95] offset:7168
    s_waitcnt lgkmcnt(0)
    ds_read_b128 v[64:67], v28 offset:0
    ds_read_b128 v[68:71], v29 offset:0
    ds_read_b128 v[72:75], v30 offset:0
    ds_read_b128 v[76:79], v31 offset:0
    ds_read_b128 v[80:83], v28 offset:4096
    ds_read_b128 v[84:87], v29 offset:4096
    ds_read_b128 v[88:91], v30 offset:4096
    ds_read_b128 v[92:95], v31 offset:4096
    v_perm_b32 v128, v100, v96, s46
    v_perm_b32 v129, v108, v104, s46
    v_perm_b32 v130, v116, v112, s46
    v_perm_b32 v131, v124, v120, s46
    v_perm_b32 v132, v100, v96, s47
    v_perm_b32 v133, v108, v104, s47
    v_perm_b32 v134, v116, v112, s47
    v_perm_b32 v135, v124, v120, s47
    v_perm_b32 v136, v101, v97, s46
    v_perm_b32 v137, v109, v105, s46
    v_perm_b32 v138, v117, v113, s46
    v_perm_b32 v139, v125, v121, s46
    v_perm_b32 v140, v101, v97, s47
    v_perm_b32 v141, v109, v105, s47
    v_perm_b32 v142, v117, v113, s47
    v_perm_b32 v143, v125, v121, s47
    v_perm_b32 v144, v102, v98, s46
    v_perm_b32 v145, v110, v106, s46
    v_perm_b32 v146, v118, v114, s46
    v_perm_b32 v147, v126, v122, s46
    v_perm_b32 v148, v102, v98, s47
    v_perm_b32 v149, v110, v106, s47
    v_perm_b32 v150, v118, v114, s47
    v_perm_b32 v151, v126, v122, s47
    v_perm_b32 v152, v103, v99, s46
    v_perm_b32 v153, v111, v107, s46
    v_perm_b32 v154, v119, v115, s46
    v_perm_b32 v155, v127, v123, s46
    v_perm_b32 v156, v103, v99, s47
    v_perm_b32 v157, v111, v107, s47
    v_perm_b32 v158, v119, v115, s47
    v_perm_b32 v159, v127, v123, s47
    s_waitcnt lgkmcnt(0)
    s_getreg_b32 s21, hwreg(HW_REG_XCC_ID)
    s_and_b32 s21, s21, 15
    s_lshl_b32 s66, s21, 8
    v_or_b32 v16, s66, v13
    s_lshl_b32 s66, s7, 7
    s_lshl_b32 s67, s8, 2
    s_add_u32 s66, s66, s67
    s_add_u32 s66, s66, 106496
    s_cmp_lg_u32 s6, 0
    s_cbranch_scc1 L_e_notbl
    s_mov_b32 exec_lo, 1
    s_mov_b32 exec_hi, 0
    buffer_store_dword v16, v239, s[48:51], s66 offen sc1
    s_mov_b64 exec, -1
L_e_notbl:
    s_waitcnt vmcnt(8)
    v_lshlrev_b32 v228, 16, v228
    v_lshlrev_b32 v229, 16, v229
    v_lshlrev_b32 v230, 16, v230
    v_lshlrev_b32 v231, 16, v231
    v_mul_f32 v16, 0xbfb8aa3b, v228
    v_mul_f32 v17, 0xbfb8aa3b, v229
    v_mul_f32 v18, 0xbfb8aa3b, v230
    v_mul_f32 v19, 0xbfb8aa3b, v231
    v_exp_f32 v16, v16
    v_exp_f32 v17, v17
    v_exp_f32 v18, v18
    v_exp_f32 v19, v19
    v_add_f32 v16, 1.0, v16
    v_add_f32 v17, 1.0, v17
    v_add_f32 v18, 1.0, v18
    v_add_f32 v19, 1.0, v19
    v_rcp_f32 v16, v16
    v_rcp_f32 v17, v17
    v_rcp_f32 v18, v18
    v_rcp_f32 v19, v19
    v_mul_f32 v16, v228, v16
    v_mul_f32 v17, v229, v17
    v_mul_f32 v18, v230, v18
    v_mul_f32 v19, v231, v19
    v_cvt_pk_bf16_f32 v20, v16, v17
    v_cvt_pk_bf16_f32 v21, v18, v19
    ds_write_b64 v248, v[20:21]
    s_waitcnt vmcnt(0)
    v_perm_b32 v96, v164, v160, s46
    v_perm_b32 v97, v172, v168, s46
    v_perm_b32 v98, v180, v176, s46
    v_perm_b32 v99, v188, v184, s46
    v_perm_b32 v100, v164, v160, s47
    v_perm_b32 v101, v172, v168, s47
    v_perm_b32 v102, v180, v176, s47
    v_perm_b32 v103, v188, v184, s47
    v_perm_b32 v104, v165, v161, s46
    v_perm_b32 v105, v173, v169, s46
    v_perm_b32 v106, v181, v177, s46
    v_perm_b32 v107, v189, v185, s46
    v_perm_b32 v108, v165, v161, s47
    v_perm_b32 v109, v173, v169, s47
    v_perm_b32 v110, v181, v177, s47
    v_perm_b32 v111, v189, v185, s47
    v_perm_b32 v112, v166, v162, s46
    v_perm_b32 v113, v174, v170, s46
    v_perm_b32 v114, v182, v178, s46
    v_perm_b32 v115, v190, v186, s46
    v_perm_b32 v116, v166, v162, s47
    v_perm_b32 v117, v174, v170, s47
    v_perm_b32 v118, v182, v178, s47
    v_perm_b32 v119, v190, v186, s47
    v_perm_b32 v120, v167, v163, s46
    v_perm_b32 v121, v175, v171, s46
    v_perm_b32 v122, v183, v179, s46
    v_perm_b32 v123, v191, v187, s46
    v_perm_b32 v124, v167, v163, s47
    v_perm_b32 v125, v175, v171, s47
    v_perm_b32 v126, v183, v179, s47
    v_perm_b32 v127, v191, v187, s47
L_ea_sec0:
    s_waitcnt lgkmcnt(0)
    ds_read_b128 v[200:203], v249 offset:0
    ds_read_b128 v[204:207], v250 offset:0
    ds_read_b128 v[208:211], v251 offset:0
    ds_read_b128 v[212:215], v252 offset:0
    s_waitcnt lgkmcnt(3)
    v_mfma_f32_16x16x32_bf16 v[192:195], v[96:99], v[200:203], 0
    v_mfma_f32_16x16x32_bf16 v[196:199], v[112:115], v[200:203], 0
    s_waitcnt lgkmcnt(2)
    v_mfma_f32_16x16x32_bf16 v[192:195], v[100:103], v[204:207], v[192:195]
    v_mfma_f32_16x16x32_bf16 v[196:199], v[116:119], v[204:207], v[196:199]
    s_waitcnt lgkmcnt(1)
    v_mfma_f32_16x16x32_bf16 v[192:195], v[104:107], v[208:211], v[192:195]
    v_mfma_f32_16x16x32_bf16 v[196:199], v[120:123], v[208:211], v[196:199]
    s_waitcnt lgkmcnt(0)
    v_mfma_f32_16x16x32_bf16 v[192:195], v[108:111], v[212:215], v[192:195]
    v_mfma_f32_16x16x32_bf16 v[196:199], v[124:127], v[212:215], v[196:199]
    s_mov_b32 exec_lo, 0x33333333
    s_mov_b32 exec_hi, 0xcccccccc
    s_nop 4
    ds_write_b128 v253, v[192:195]
    ds_write_b128 v253, v[196:199] offset:1088
    s_mov_b64 exec, -1
    s_waitcnt lgkmcnt(0)
    s_cmp_lg_u32 s96, 0
    s_cbranch_scc1 L_ea_sec1
    s_barrier
    s_cmp_ge_u32 s6, 4
    s_cbranch_scc1 L_epi_done_ea
L_ea_sec1:
    ds_read_b128 v[20:23], v254
    ds_read_b128 v[24:27], v254 offset:16
    s_waitcnt lgkmcnt(0)
    v_pk_add_f32 v[20:21], v[20:21], v[24:25]
    v_pk_add_f32 v[22:23], v[22:23], v[26:27]
    s_nop 0
    v_add_f32_dpp v20, v20, v20 quad_perm:[1,0,3,2] row_mask:0xf bank_mask:0xf
    v_add_f32_dpp v21, v21, v21 quad_perm:[1,0,3,2] row_mask:0xf bank_mask:0xf
    v_add_f32_dpp v22, v22, v22 quad_perm:[1,0,3,2] row_mask:0xf bank_mask:0xf
    v_add_f32_dpp v23, v23, v23 quad_perm:[1,0,3,2] row_mask:0xf bank_mask:0xf
    v_add_f32_dpp v20, v20, v20 quad_perm:[2,3,0,1] row_mask:0xf bank_mask:0xf
    v_add_f32_dpp v21, v21, v21 quad_perm:[2,3,0,1] row_mask:0xf bank_mask:0xf
    v_add_f32_dpp v22, v22, v22 quad_perm:[2,3,0,1] row_mask:0xf bank_mask:0xf
    v_add_f32_dpp v23, v23, v23 quad_perm:[2,3,0,1] row_mask:0xf bank_mask:0xf
    v_add_f32_dpp v20, v20, v20 row_half_mirror row_mask:0xf bank_mask:0xf
    v_add_f32_dpp v21, v21, v21 row_half_mirror row_mask:0xf bank_mask:0xf
    v_add_f32_dpp v22, v22, v22 row_half_mirror row_mask:0xf bank_mask:0xf
    v_add_f32_dpp v23, v23, v23 row_half_mirror row_mask:0xf bank_mask:0xf
    v_add_u32 v20, 0x80, v20
    v_add_u32 v21, 0x80, v21
    v_add_u32 v22, 0x80, v22
    v_add_u32 v23, 0x80, v23
    v_and_or_b32 v24, v20, s26, v13
    v_and_or_b32 v25, v21, s26, v13
    v_and_or_b32 v26, v22, s26, v13
    v_and_or_b32 v27, v23, s26, v13
    s_mov_b32 exec_lo, 0x01010101
    s_mov_b32 exec_hi, 0x01010101
    s_cmp_lg_u32 s96, 0
    s_cbranch_scc1 L_nd_28
    buffer_store_dwordx4 v[24:27], v255, s[48:51], s68 offen sc1
L_nd_28:
    s_mov_b64 exec, -1
L_epi_done_ea:
    s_cmp_lg_u32 s96, 0
    s_cbranch_scc1 L_e_drydone
    s_barrier
    s_mov_b32 s68, s15
    v_and_b32 v246, 31, v1
    v_min_u32 v246, 19, v246
    v_lshlrev_b32 v246, 2, v246
    s_lshl_b32 s20, s7, 7
    s_add_u32 s20, s20, 106496
L_e_qpoll:
L_e_sec0:
    s_add_u32 s66, s97, 32768
    s_mov_b32 s70, 200000
L_poll_29:
    s_cmp_lg_u32 s96, 0
    s_cbranch_scc1 L_psk_31
    buffer_load_dwordx4 v[20:23], v4, s[48:51], s97 offen sc1
    buffer_load_dwordx4 v[24:27], v4, s[48:51], s66 offen sc1
    buffer_load_dwordx2 v[28:29], v246, s[48:51], s20 offen sc1
    s_waitcnt vmcnt(0)
L_psk_31:
    v_xor_b32 v20, v13, v20
    v_xor_b32 v21, v13, v21
    v_or_b32 v16, v20, v21
    v_xor_b32 v22, v13, v22
    v_xor_b32 v23, v13, v23
    v_or3_b32 v16, v16, v22, v23
    v_xor_b32 v24, v13, v24
    v_xor_b32 v25, v13, v25
    v_or3_b32 v16, v16, v24, v25
    v_xor_b32 v26, v13, v26
    v_xor_b32 v27, v13, v27
    v_or3_b32 v16, v16, v26, v27
    v_xor_b32 v28, v13, v28
    v_or3_b32 v16, v16, v28, v28
    v_and_b32 v16, 0xff, v16
    v_cmp_ne_u32 vcc, 0, v16
    s_nop 1
    s_cbranch_vccz L_pdone_30
    s_cmp_lg_u32 s96, 0
    s_cbranch_scc1 L_pdone_30
    s_sub_u32 s70, s70, 1
    s_cmp_lg_u32 s70, 0
    s_cbranch_scc1 L_poll_29
L_pdone_30:
    v_lshrrev_b32 v28, 8, v28
    v_cmp_ne_u32 vcc, s21, v28
    s_nop 1
    s_cmp_eq_u64 vcc, 0
    s_cselect_b32 s18, 1966080, 0
    s_cselect_b32 s19, 1703936, 0
    v_pk_add_f32 v[20:21], v[20:21], v[24:25]
    v_pk_add_f32 v[22:23], v[22:23], v[26:27]
    v_cvt_pk_bf16_f32 v20, v20, v21
    v_cvt_pk_bf16_f32 v22, v22, v23
    ds_write_b16 v5, v20 offset:0
    ds_write_b16_d16_hi v5, v20 offset:16
    ds_write_b16 v5, v22 offset:32
    ds_write_b16_d16_hi v5, v22 offset:48
    s_waitcnt lgkmcnt(0)
    s_cmp_lg_u32 s96, 0
    s_cbranch_scc1 L_e_drydone
    s_barrier
L_e_sec1:
    ds_read_b128 v[24:27], v6 offset:0
    ds_read_b128 v[28:31], v6 offset:64
    ds_read_b128 v[32:35], v6 offset:128
    ds_read_b128 v[36:39], v6 offset:192
    s_waitcnt lgkmcnt(3)
    v_mfma_f32_16x16x32_bf16 v[40:43], v[64:67], v[24:27], 0
    v_mfma_f32_16x16x32_bf16 v[44:47], v[80:83], v[24:27], 0
    s_waitcnt lgkmcnt(2)
    v_mfma_f32_16x16x32_bf16 v[40:43], v[68:71], v[28:31], v[40:43]
    v_mfma_f32_16x16x32_bf16 v[44:47], v[84:87], v[28:31], v[44:47]
    s_waitcnt lgkmcnt(1)
    v_mfma_f32_16x16x32_bf16 v[40:43], v[72:75], v[32:35], v[40:43]
    v_mfma_f32_16x16x32_bf16 v[44:47], v[88:91], v[32:35], v[44:47]
    s_waitcnt lgkmcnt(0)
    v_mfma_f32_16x16x32_bf16 v[40:43], v[76:79], v[36:39], v[40:43]
    v_mfma_f32_16x16x32_bf16 v[44:47], v[92:95], v[36:39], v[44:47]
    s_mov_b32 s67, 0x3fb8aa3b
    s_mov_b32 s31, 0x3db504f3
    s_nop 4
    v_cvt_pk_bf16_f32 v48, v40, v41
    v_cvt_pk_bf16_f32 v49, v42, v43
    v_lshlrev_b32 v40, 16, v48
    v_and_b32 v41, 0xffff0000, v48
    v_lshlrev_b32 v42, 16, v49
    v_and_b32 v43, 0xffff0000, v49
    v_cvt_pk_bf16_f32 v50, v44, v45
    v_cvt_pk_bf16_f32 v51, v46, v47
    v_lshlrev_b32 v44, 16, v50
    v_and_b32 v45, 0xffff0000, v50
    v_lshlrev_b32 v46, 16, v51
    v_and_b32 v47, 0xffff0000, v51
    v_pk_mul_f32 v[40:41], v[40:41], s[30:31] op_sel:[0,1] op_sel_hi:[1,1]
    v_pk_mul_f32 v[42:43], v[42:43], s[30:31] op_sel:[0,1] op_sel_hi:[1,1]
    v_pk_mul_f32 v[44:45], v[44:45], s[30:31] op_sel:[0,1] op_sel_hi:[1,1]
    v_pk_mul_f32 v[46:47], v[46:47], s[30:31] op_sel:[0,1] op_sel_hi:[1,1]
    v_cvt_pk_bf16_f32 v48, v40, v41
    v_cvt_pk_bf16_f32 v49, v42, v43
    v_lshlrev_b32 v40, 16, v48
    v_and_b32 v41, 0xffff0000, v48
    v_lshlrev_b32 v42, 16, v49
    v_and_b32 v43, 0xffff0000, v49
    v_cvt_pk_bf16_f32 v50, v44, v45
    v_cvt_pk_bf16_f32 v51, v46, v47
    v_lshlrev_b32 v44, 16, v50
    v_and_b32 v45, 0xffff0000, v50
    v_lshlrev_b32 v46, 16, v51
    v_and_b32 v47, 0xffff0000, v51
    v_max3_f32 v16, v40, v41, v42
    v_max3_f32 v17, v43, v44, v45
    v_max3_f32 v16, v16, v46, v47
    v_max_f32 v16, v16, v17
    v_mov_b32 v17, v16
    s_nop 1
    v_permlane16_swap_b32 v16, v17
    v_max_f32 v16, v16, v17
    v_mov_b32 v17, v16
    s_nop 1
    v_permlane32_swap_b32 v16, v17
    v_max_f32 v16, v16, v17
    s_cmp_lg_u32 s96, 0
    s_cbranch_scc1 L_e_drydone
L_e_sec2:
    s_mov_b32 s67, 0x3fb8aa3b
    v_mul_f32 v17, 0xbfb8aa3b, v16
    ds_write_b32 v7, v16 offset:2304
    v_fma_f32 v40, v40, s67, v17
    v_fma_f32 v41, v41, s67, v17
    v_fma_f32 v42, v42, s67, v17
    v_fma_f32 v43, v43, s67, v17
    v_fma_f32 v44, v44, s67, v17
    v_fma_f32 v45, v45, s67, v17
    v_fma_f32 v46, v46, s67, v17
    v_fma_f32 v47, v47, s67, v17
    v_exp_f32 v40, v40
    v_exp_f32 v41, v41
    v_exp_f32 v42, v42
    v_exp_f32 v43, v43
    v_exp_f32 v44, v44
    v_exp_f32 v45, v45
    v_exp_f32 v46, v46
    v_exp_f32 v47, v47
    v_cvt_pk_bf16_f32 v48, v40, v41
    v_cvt_pk_bf16_f32 v49, v42, v43
    v_cvt_pk_bf16_f32 v50, v44, v45
    v_cvt_pk_bf16_f32 v51, v46, v47
    v_cndmask_b32 v60, v48, v239, s[34:35]
    v_cndmask_b32 v61, v49, v239, s[34:35]
    v_cndmask_b32 v62, v50, v239, s[34:35]
    v_cndmask_b32 v63, v51, v239, s[34:35]
    v_cndmask_b32 v56, v239, v48, s[34:35]
    v_cndmask_b32 v57, v239, v49, s[34:35]
    v_cndmask_b32 v58, v239, v50, s[34:35]
    v_cndmask_b32 v59, v239, v51, s[34:35]
    v_mfma_f32_16x16x32_bf16 v[192:195], v[128:131], v[60:63], 0
    v_mfma_f32_16x16x32_bf16 v[196:199], v[136:139], v[60:63], 0
    v_mfma_f32_16x16x32_bf16 v[200:203], v[144:147], v[60:63], 0
    v_mfma_f32_16x16x32_bf16 v[204:207], v[152:155], v[60:63], 0
    v_mfma_f32_16x16x32_bf16 v[192:195], v[132:135], v[56:59], v[192:195]
    v_mfma_f32_16x16x32_bf16 v[196:199], v[140:143], v[56:59], v[196:199]
    v_mfma_f32_16x16x32_bf16 v[200:203], v[148:151], v[56:59], v[200:203]
    v_mfma_f32_16x16x32_bf16 v[204:207], v[156:159], v[56:59], v[204:207]
    v_add_f32 v18, v40, v41
    v_add_f32 v19, v42, v43
    v_add_f32 v20, v44, v45
    v_add_f32 v21, v46, v47
    v_add_f32 v18, v18, v19
    v_add_f32 v20, v20, v21
    v_add_f32 v18, v18, v20
    v_mov_b32 v19, v18
    s_nop 1
    v_permlane16_swap_b32 v18, v19
    v_add_f32 v18, v18, v19
    v_mov_b32 v19, v18
    s_nop 1
    v_permlane32_swap_b32 v18, v19
    v_add_f32 v18, v18, v19
    ds_write_b32 v7, v18 offset:2560
    ds_write_b128 v240, v[192:195]
    ds_write_b128 v241, v[196:199]
    ds_write_b128 v242, v[200:203]
    ds_write_b128 v243, v[204:207]
    s_waitcnt lgkmcnt(0)
    s_cmp_lg_u32 s96, 0
    s_cbranch_scc1 L_e_drydone
    s_barrier
L_e_sec3:
    ds_read_b128 v[48:51], v11 offset:2304
    ds_read_b128 v[52:55], v11 offset:2560
    ds_read_b128 v[20:23], v9 offset:0
    ds_read_b128 v[24:27], v9 offset:8448
    ds_read_b128 v[28:31], v9 offset:16896
    ds_read_b128 v[32:35], v9 offset:25344
    s_waitcnt lgkmcnt(4)
    v_max3_f32 v16, v48, v49, v50
    v_max_f32 v16, v16, v51
    s_nop 1
    v_max_f32_dpp v16, v16, v16 quad_perm:[1,0,3,2] row_mask:0xf bank_mask:0xf
    v_mul_f32 v17, 0xbfb8aa3b, v16
    v_fma_f32 v48, v48, s67, v17
    v_fma_f32 v49, v49, s67, v17
    v_fma_f32 v50, v50, s67, v17
    v_fma_f32 v51, v51, s67, v17
    v_exp_f32 v48, v48
    v_exp_f32 v49, v49
    v_exp_f32 v50, v50
    v_exp_f32 v51, v51
    v_mul_f32 v18, v48, v52
    v_fmac_f32 v18, v49, v53
    v_fmac_f32 v18, v50, v54
    v_fmac_f32 v18, v51, v55
    s_waitcnt lgkmcnt(0)
    v_pk_mul_f32 v[20:21], v[20:21], v[48:49] op_sel_hi:[1,0]
    v_pk_mul_f32 v[22:23], v[22:23], v[48:49] op_sel_hi:[1,0]
    v_pk_fma_f32 v[20:21], v[24:25], v[48:49], v[20:21] op_sel:[0,1,0] op_sel_hi:[1,1,1]
    v_pk_fma_f32 v[22:23], v[26:27], v[48:49], v[22:23] op_sel:[0,1,0] op_sel_hi:[1,1,1]
    v_pk_fma_f32 v[20:21], v[28:29], v[50:51], v[20:21] op_sel_hi:[1,0,1]
    v_pk_fma_f32 v[22:23], v[30:31], v[50:51], v[22:23] op_sel_hi:[1,0,1]
    v_pk_fma_f32 v[20:21], v[32:33], v[50:51], v[20:21] op_sel:[0,1,0] op_sel_hi:[1,1,1]
    v_pk_fma_f32 v[22:23], v[34:35], v[50:51], v[22:23] op_sel:[0,1,0] op_sel_hi:[1,1,1]
    v_add_f32_dpp v18, v18, v18 quad_perm:[1,0,3,2] row_mask:0xf bank_mask:0xf
    v_add_f32_dpp v20, v20, v20 quad_perm:[1,0,3,2] row_mask:0xf bank_mask:0xf
    v_add_f32_dpp v21, v21, v21 quad_perm:[1,0,3,2] row_mask:0xf bank_mask:0xf
    v_add_f32_dpp v22, v22, v22 quad_perm:[1,0,3,2] row_mask:0xf bank_mask:0xf
    v_add_f32_dpp v23, v23, v23 quad_perm:[1,0,3,2] row_mask:0xf bank_mask:0xf
    v_and_or_b32 v24, v20, s26, v13
    v_and_or_b32 v25, v21, s26, v13
    v_and_or_b32 v26, v22, s26, v13
    v_and_or_b32 v27, v23, s26, v13
    v_and_or_b32 v16, v16, s26, v13
    v_and_or_b32 v17, v18, s26, v13
    s_mov_b32 exec_lo, 0x55555555
    s_mov_b32 exec_hi, 0x55555555
    s_add_u32 s66, s68, s18
    s_add_u32 s73, s72, s19
    s_cmp_eq_u32 s18, 0
    s_cbranch_scc1 L_e_pubg
    s_cmp_lg_u32 s96, 0
    s_cbranch_scc1 L_nd_32
    buffer_store_dwordx4 v[24:27], v10, s[48:51], s66 offen
L_nd_32:
    s_mov_b32 exec_lo, 0x00000001
    s_mov_b32 exec_hi, 0x00000000
    s_cmp_lg_u32 s96, 0
    s_cbranch_scc1 L_nd_33
    buffer_store_dwordx2 v[16:17], v239, s[48:51], s73 offen
L_nd_33:
    s_branch L_e_pubd
L_e_pubg:
    s_cmp_lg_u32 s96, 0
    s_cbranch_scc1 L_nd_34
    buffer_store_dwordx4 v[24:27], v10, s[48:51], s68 offen sc1
L_nd_34:
    s_mov_b32 exec_lo, 0x00000001
    s_mov_b32 exec_hi, 0x00000000
    s_cmp_lg_u32 s96, 0
    s_cbranch_scc1 L_nd_35
    buffer_store_dwordx2 v[16:17], v239, s[48:51], s72 offen sc1
L_nd_35:
L_e_pubd:
    s_mov_b64 exec, -1
    s_cmp_lg_u32 s96, 0
    s_cbranch_scc1 L_e_drydone
    s_cmp_lg_u32 s6, 0
    s_cbranch_scc1 L_E_nostat
L_e_sec4:
    s_add_u32 s40, s16, s18
    s_add_u32 s41, s23, s18
    s_add_u32 s42, s24, s18
    s_add_u32 s43, s25, s18
    s_add_u32 s74, s17, s19
    s_add_u32 s66, s74, 4096
    s_add_u32 s67, s74, 8192
    s_add_u32 s73, s74, 12288
    s_mov_b32 s70, 200000
L_poll_36:
    s_cmp_lg_u32 s96, 0
    s_cbranch_scc1 L_psk_38
    buffer_load_dwordx4 v[24:27], v232, s[48:51], s40 offen sc1
    buffer_load_dwordx4 v[28:31], v232, s[48:51], s41 offen sc1
    buffer_load_dwordx4 v[32:35], v232, s[48:51], s42 offen sc1
    buffer_load_dwordx4 v[36:39], v232, s[48:51], s43 offen sc1
    buffer_load_dwordx2 v[40:41], v233, s[48:51], s74 offen sc1
    buffer_load_dwordx2 v[42:43], v233, s[48:51], s66 offen sc1
    buffer_load_dwordx2 v[44:45], v233, s[48:51], s67 offen sc1
    buffer_load_dwordx2 v[46:47], v233, s[48:51], s73 offen sc1
    s_waitcnt vmcnt(0)
L_psk_38:
    v_xor_b32 v24, v13, v24
    v_xor_b32 v25, v13, v25
    v_or_b32 v48, v24, v25
    v_xor_b32 v26, v13, v26
    v_xor_b32 v27, v13, v27
    v_or3_b32 v48, v48, v26, v27
    v_xor_b32 v28, v13, v28
    v_xor_b32 v29, v13, v29
    v_or3_b32 v48, v48, v28, v29
    v_xor_b32 v30, v13, v30
    v_xor_b32 v31, v13, v31
    v_or3_b32 v48, v48, v30, v31
    v_xor_b32 v32, v13, v32
    v_xor_b32 v33, v13, v33
    v_or3_b32 v48, v48, v32, v33
    v_xor_b32 v34, v13, v34
    v_xor_b32 v35, v13, v35
    v_or3_b32 v48, v48, v34, v35
    v_xor_b32 v36, v13, v36
    v_xor_b32 v37, v13, v37
    v_or3_b32 v48, v48, v36, v37
    v_xor_b32 v38, v13, v38
    v_xor_b32 v39, v13, v39
    v_or3_b32 v48, v48, v38, v39
    v_xor_b32 v40, v13, v40
    v_xor_b32 v41, v13, v41
    v_or3_b32 v48, v48, v40, v41
    v_xor_b32 v42, v13, v42
    v_xor_b32 v43, v13, v43
    v_or3_b32 v48, v48, v42, v43
    v_xor_b32 v44, v13, v44
    v_xor_b32 v45, v13, v45
    v_or3_b32 v48, v48, v44, v45
    v_xor_b32 v46, v13, v46
    v_xor_b32 v47, v13, v47
    v_or3_b32 v48, v48, v46, v47
    v_and_b32 v48, 0xff, v48
    v_cmp_ne_u32 vcc, 0, v48
    s_nop 1
    s_cbranch_vccz L_pdone_37
    s_cmp_lg_u32 s96, 0
    s_cbranch_scc1 L_pdone_37
    s_sub_u32 s70, s70, 1
    s_cmp_lg_u32 s70, 0
    s_cbranch_scc1 L_poll_36
L_pdone_37:
    v_max3_f32 v48, v40, v42, v44
    v_max_f32 v48, v48, v46
    s_mov_b32 s67, 0x3fb8aa3b
    s_nop 0
    v_max_f32_dpp v48, v48, v48 quad_perm:[1,0,3,2] row_mask:0xf bank_mask:0xf
    s_nop 1
    v_max_f32_dpp v48, v48, v48 quad_perm:[2,3,0,1] row_mask:0xf bank_mask:0xf
    v_mul_f32 v49, 0xbfb8aa3b, v48
    v_fma_f32 v50, v40, s67, v49
    v_fma_f32 v51, v42, s67, v49
    v_fma_f32 v52, v44, s67, v49
    v_fma_f32 v53, v46, s67, v49
    v_exp_f32 v50, v50
    v_exp_f32 v51, v51
    v_exp_f32 v52, v52
    v_exp_f32 v53, v53
    v_mul_f32 v54, v50, v41
    v_pk_mul_f32 v[56:57], v[24:25], v[50:51] op_sel_hi:[1,0]
    v_pk_mul_f32 v[58:59], v[26:27], v[50:51] op_sel_hi:[1,0]
    v_fmac_f32 v54, v51, v43
    v_pk_fma_f32 v[56:57], v[28:29], v[50:51], v[56:57] op_sel:[0,1,0] op_sel_hi:[1,1,1]
    v_pk_fma_f32 v[58:59], v[30:31], v[50:51], v[58:59] op_sel:[0,1,0] op_sel_hi:[1,1,1]
    v_fmac_f32 v54, v52, v45
    v_pk_fma_f32 v[56:57], v[32:33], v[52:53], v[56:57] op_sel_hi:[1,0,1]
    v_pk_fma_f32 v[58:59], v[34:35], v[52:53], v[58:59] op_sel_hi:[1,0,1]
    v_fmac_f32 v54, v53, v47
    v_pk_fma_f32 v[56:57], v[36:37], v[52:53], v[56:57] op_sel:[0,1,0] op_sel_hi:[1,1,1]
    v_pk_fma_f32 v[58:59], v[38:39], v[52:53], v[58:59] op_sel:[0,1,0] op_sel_hi:[1,1,1]
    v_add_f32_dpp v54, v54, v54 quad_perm:[1,0,3,2] row_mask:0xf bank_mask:0xf
    v_add_f32_dpp v56, v56, v56 quad_perm:[1,0,3,2] row_mask:0xf bank_mask:0xf
    v_add_f32_dpp v57, v57, v57 quad_perm:[1,0,3,2] row_mask:0xf bank_mask:0xf
    v_add_f32_dpp v58, v58, v58 quad_perm:[1,0,3,2] row_mask:0xf bank_mask:0xf
    v_add_f32_dpp v59, v59, v59 quad_perm:[1,0,3,2] row_mask:0xf bank_mask:0xf
    v_add_f32_dpp v54, v54, v54 quad_perm:[2,3,0,1] row_mask:0xf bank_mask:0xf
    v_add_f32_dpp v56, v56, v56 quad_perm:[2,3,0,1] row_mask:0xf bank_mask:0xf
    v_add_f32_dpp v57, v57, v57 quad_perm:[2,3,0,1] row_mask:0xf bank_mask:0xf
    v_add_f32_dpp v58, v58, v58 quad_perm:[2,3,0,1] row_mask:0xf bank_mask:0xf
    v_add_f32_dpp v59, v59, v59 quad_perm:[2,3,0,1] row_mask:0xf bank_mask:0xf
    v_rcp_f32 v54, v54
    s_nop 0
    v_pk_mul_f32 v[56:57], v[56:57], v[54:55] op_sel_hi:[1,0]
    v_pk_mul_f32 v[58:59], v[58:59], v[54:55] op_sel_hi:[1,0]
    v_cvt_pk_bf16_f32 v61, v56, v57
    v_cvt_pk_bf16_f32 v63, v58, v59
    v_lshl_or_b32 v60, v61, 16, v12
    v_lshl_or_b32 v62, v63, 16, v12
    v_and_or_b32 v61, v61, s71, v12
    v_and_or_b32 v63, v63, s71, v12
    s_mov_b32 exec_lo, 0x11111111
    s_mov_b32 exec_hi, 0x11111111
    s_cmp_lg_u32 s96, 0
    s_cbranch_scc1 L_nd_39
    buffer_store_dwordx4 v[60:63], v234, s[48:51], s22 offen sc1
L_nd_39:
    s_mov_b64 exec, -1
L_E_nostat:
    s_cmp_lg_u32 s96, 0
    s_cbranch_scc1 L_e_drydone
    s_barrier
    s_cmp_ge_u32 s6, 7
    s_cbranch_scc1 L_E_dskip
    s_add_u32 s66, s29, 0
    buffer_load_dwordx4 v[64:67], v235, s[60:63], s66 offen nt
    s_add_u32 s66, s29, 16384
    buffer_load_dwordx4 v[68:71], v235, s[60:63], s66 offen nt
    s_add_u32 s66, s29, 32768
    buffer_load_dwordx4 v[72:75], v235, s[60:63], s66 offen nt
    s_add_u32 s66, s29, 49152
    buffer_load_dwordx4 v[76:79], v235, s[60:63], s66 offen nt
    s_add_u32 s66, s29, 2048
    buffer_load_dwordx4 v[80:83], v235, s[60:63], s66 offen nt
    s_add_u32 s66, s29, 18432
    buffer_load_dwordx4 v[84:87], v235, s[60:63], s66 offen nt
    s_add_u32 s66, s29, 34816
    buffer_load_dwordx4 v[88:91], v235, s[60:63], s66 offen nt
    s_add_u32 s66, s29, 51200
    buffer_load_dwordx4 v[92:95], v235, s[60:63], s66 offen nt
    s_waitcnt vmcnt(0)
    v_perm_b32 v160, v68, v64, s46
    v_perm_b32 v161, v76, v72, s46
    v_perm_b32 v162, v84, v80, s46
    v_perm_b32 v163, v92, v88, s46
    v_perm_b32 v164, v68, v64, s47
    v_perm_b32 v165, v76, v72, s47
    v_perm_b32 v166, v84, v80, s47
    v_perm_b32 v167, v92, v88, s47
    v_perm_b32 v168, v69, v65, s46
    v_perm_b32 v169, v77, v73, s46
    v_perm_b32 v170, v85, v81, s46
    v_perm_b32 v171, v93, v89, s46
    v_perm_b32 v172, v69, v65, s47
    v_perm_b32 v173, v77, v73, s47
    v_perm_b32 v174, v85, v81, s47
    v_perm_b32 v175, v93, v89, s47
    v_perm_b32 v176, v70, v66, s46
    v_perm_b32 v177, v78, v74, s46
    v_perm_b32 v178, v86, v82, s46
    v_perm_b32 v179, v94, v90, s46
    v_perm_b32 v180, v70, v66, s47
    v_perm_b32 v181, v78, v74, s47
    v_perm_b32 v182, v86, v82, s47
    v_perm_b32 v183, v94, v90, s47
    v_perm_b32 v184, v71, v67, s46
    v_perm_b32 v185, v79, v75, s46
    v_perm_b32 v186, v87, v83, s46
    v_perm_b32 v187, v95, v91, s46
    v_perm_b32 v188, v71, v67, s47
    v_perm_b32 v189, v79, v75, s47
    v_perm_b32 v190, v87, v83, s47
    v_perm_b32 v191, v95, v91, s47
L_e_sec5:
    s_mov_b32 s70, 200000
L_poll_40:
    s_cmp_lg_u32 s96, 0
    s_cbranch_scc1 L_psk_42
    buffer_load_dwordx4 v[20:23], v236, s[48:51], s28 offen sc1
    buffer_load_dwordx4 v[24:27], v236, s[48:51], s28 offen offset:16 sc1
    s_waitcnt vmcnt(0)
L_psk_42:
    v_xor_b32 v20, v12, v20
    v_xor_b32 v21, v12, v21
    v_or_b32 v16, v20, v21
    v_xor_b32 v22, v12, v22
    v_xor_b32 v23, v12, v23
    v_or3_b32 v16, v16, v22, v23
    v_xor_b32 v24, v12, v24
    v_xor_b32 v25, v12, v25
    v_or3_b32 v16, v16, v24, v25
    v_xor_b32 v26, v12, v26
    v_xor_b32 v27, v12, v27
    v_or3_b32 v16, v16, v26, v27
    v_and_b32 v16, 0xffff, v16
    v_cmp_ne_u32 vcc, 0, v16
    s_nop 1
    s_cbranch_vccz L_pdone_41
    s_cmp_lg_u32 s96, 0
    s_cbranch_scc1 L_pdone_41
    s_sub_u32 s70, s70, 1
    s_cmp_lg_u32 s70, 0
    s_cbranch_scc1 L_poll_40
L_pdone_41:
    v_perm_b32 v28, v21, v20, s47
    v_perm_b32 v29, v23, v22, s47
    v_perm_b32 v30, v25, v24, s47
    v_perm_b32 v31, v27, v26, s47
    s_nop 1
    v_mfma_f32_16x16x32_bf16 v[192:195], v[160:163], v[28:31], 0
    v_mfma_f32_16x16x32_bf16 v[196:199], v[164:167], v[28:31], 0
    v_mfma_f32_16x16x32_bf16 v[200:203], v[168:171], v[28:31], 0
    v_mfma_f32_16x16x32_bf16 v[204:207], v[172:175], v[28:31], 0
    v_mfma_f32_16x16x32_bf16 v[208:211], v[176:179], v[28:31], 0
    v_mfma_f32_16x16x32_bf16 v[212:215], v[180:183], v[28:31], 0
    v_mfma_f32_16x16x32_bf16 v[216:219], v[184:187], v[28:31], 0
    v_mfma_f32_16x16x32_bf16 v[220:223], v[188:191], v[28:31], 0
    s_mov_b32 exec_lo, 0x00030003
    s_mov_b32 exec_hi, 0x00030003
    ds_write_b128 v237, v[192:195] offset:0
    ds_write_b128 v237, v[196:199] offset:16
    ds_write_b128 v237, v[200:203] offset:32
    ds_write_b128 v237, v[204:207] offset:48
    ds_write_b128 v237, v[208:211] offset:64
    ds_write_b128 v237, v[212:215] offset:80
    ds_write_b128 v237, v[216:219] offset:96
    ds_write_b128 v237, v[220:223] offset:112
    s_mov_b64 exec, -1
    s_waitcnt lgkmcnt(0)
L_E_dskip:
    s_cmp_lg_u32 s96, 0
    s_cbranch_scc1 L_e_drydone
    s_barrier
    s_cmp_lg_u32 s6, 0
    s_cbranch_scc1 L_E_pend
L_e_sec6:
    v_add_u32 v17, 4096, v238
    ds_read_b128 v[20:23], v17 offset:0
    ds_read_b128 v[24:27], v17 offset:1024
    ds_read_b128 v[28:31], v17 offset:2048
    ds_read_b128 v[32:35], v17 offset:3072
    ds_read_b128 v[36:39], v17 offset:4096
    ds_read_b128 v[40:43], v17 offset:5120
    ds_read_b128 v[44:47], v17 offset:6144
    s_waitcnt lgkmcnt(0)
    v_pk_add_f32 v[20:21], v[20:21], v[24:25]
    v_pk_add_f32 v[22:23], v[22:23], v[26:27]
    v_pk_add_f32 v[28:29], v[28:29], v[32:33]
    v_pk_add_f32 v[30:31], v[30:31], v[34:35]
    v_pk_add_f32 v[36:37], v[36:37], v[40:41]
    v_pk_add_f32 v[38:39], v[38:39], v[42:43]
    v_pk_add_f32 v[20:21], v[20:21], v[28:29]
    v_pk_add_f32 v[22:23], v[22:23], v[30:31]
    v_pk_add_f32 v[36:37], v[36:37], v[44:45]
    v_pk_add_f32 v[38:39], v[38:39], v[46:47]
    v_pk_add_f32 v[20:21], v[20:21], v[36:37]
    v_pk_add_f32 v[22:23], v[22:23], v[38:39]
    v_and_or_b32 v24, v20, s26, v13
    v_and_or_b32 v25, v21, s26, v13
    v_and_or_b32 v26, v22, s26, v13
    v_and_or_b32 v27, v23, s26, v13
    s_add_u32 s66, s69, 1998848
    s_cmp_eq_u32 s18, 0
    s_cbranch_scc1 L_e_dpubg
    s_cmp_lg_u32 s96, 0
    s_cbranch_scc1 L_nd_43
    buffer_store_dwordx4 v[24:27], v238, s[48:51], s66 offen
L_nd_43:
    s_branch L_e_dpubd
L_e_dpubg:
    s_cmp_lg_u32 s96, 0
    s_cbranch_scc1 L_nd_44
    buffer_store_dwordx4 v[24:27], v238, s[48:51], s69 offen sc1
L_nd_44:
L_e_dpubd:
L_E_pend:
    s_cmp_eq_u32 s96, 0
    s_cbranch_scc1 L_e_out
L_e_drydone:
    s_mov_b32 s96, 0
    s_barrier
    s_branch L_e_real
L_e_out:
L_fin:
L_end:
    s_endpgm
L_code_end:
.section .rodata,"a"
.p2align 6
.amdhsa_kernel adaLN_cond__sliding_block_cached__mixer_channel_mlp__decode_kernel
  .amdhsa_next_free_vgpr 256
  .amdhsa_next_free_sgpr 102
  .amdhsa_accum_offset 256
  .amdhsa_group_segment_fixed_size 0
  .amdhsa_kernarg_size 120
  .amdhsa_user_sgpr_count 2
  .amdhsa_user_sgpr_kernarg_segment_ptr 1
  .amdhsa_system_sgpr_workgroup_id_x 1
.end_amdhsa_kernel
```
